```python
import torch

def _softmax(x, axis=-1):
    return torch.softmax(x, dim=axis)

def _gelu(x):
    return torch.nn.functional.gelu(x, approximate='tanh')

def _silu(x):
    return torch.nn.functional.silu(x)

def _sigmoid(x):
    return torch.sigmoid(x)

def _layernorm(x, axis=-1, eps=1e-05):
    m = x.mean(dim=axis, keepdim=True)
    v = x.var(dim=axis, keepdim=True, unbiased=False)
    return (x - m) / torch.sqrt(v + eps)

def _scatter_add(tgt, idx, src, axis=0):
    return tgt.clone().index_add_(axis, idx, src)

def _segment_sum(src, seg, n):
    out = torch.zeros((n,) + src.shape[1:], dtype=src.dtype)
    return out.index_add_(0, seg, src)

def _pad(x, pw):
    flat = tuple((v for pair in reversed(pw) for v in pair))
    return torch.nn.functional.pad(x, flat)
kernel_name = 'adaLN_cond__gqa_block_cached__geglu_ffn__decode'

def setup_inputs():

    _w = lambda a: (lambda t: t.to(torch.bfloat16) if t.is_floating_point() else t)(torch.as_tensor(a))

    def _A_setup():
        B, Sq, D = (4, 1, 640)
        Hq, Hkv, Sk, Dh = (32, 32, 4096, 192)
        assert Hq % Hkv == 0, (Hq, Hkv)
        return {'x': _w((lambda *s: torch.randn(*s, dtype=torch.bfloat16) * 0.05)(B, Sq, D)), 'k_cache': _w((lambda *s: torch.randn(*s, dtype=torch.bfloat16) * 3.2)(B, Hkv, Sk, Dh)), 'v_cache': _w((lambda *s: torch.randn(*s, dtype=torch.bfloat16) * 0.4)(B, Hkv, Sk, Dh)), 'wq': _w((lambda *s: torch.randn(*s, dtype=torch.bfloat16) * 3.2)(D, Hq * Dh) * D ** (-0.5)), 'wo': _w((lambda *s: torch.randn(*s, dtype=torch.bfloat16) * 0.4)(Hq * Dh, D) * (Hq * Dh) ** (-0.5))}
    _A_in = _A_setup()

    def _B_setup():
        B, S, D, F = (4, 1, 640, 1536)
        return {'x': _w((lambda *s: torch.randn(*s, dtype=torch.bfloat16) * 0.05)(B, S, D)), 'w_gate': _w((lambda *s: torch.randn(*s, dtype=torch.bfloat16) * 0.05)(D, F)), 'w_up': _w((lambda *s: torch.randn(*s, dtype=torch.bfloat16) * 0.05)(D, F)), 'w_down': _w((lambda *s: torch.randn(*s, dtype=torch.bfloat16) * 0.05)(F, D))}
    _B_in = _B_setup()
    return {'A_x': _A_in['x'], 'A_k_cache': _A_in['k_cache'], 'A_v_cache': _A_in['v_cache'], 'A_wq': _A_in['wq'], 'A_wo': _A_in['wo'], 'B_x': _B_in['x'], 'B_w_gate': _B_in['w_gate'], 'B_w_up': _B_in['w_up'], 'B_w_down': _B_in['w_down'], 'c': _w((lambda *s: torch.randn(*s, dtype=torch.bfloat16) * 0.1)(4, 640) * 8.0), 'w_mod': _w((lambda *s: torch.randn(*s, dtype=torch.bfloat16) * 0.1)(640, 6 * 640) * 640 ** (-0.5) * 8.0)}

def reference(A_x, A_k_cache, A_v_cache, A_wq, A_wo, B_x, B_w_gate, B_w_up, B_w_down, c, w_mod):

    def _A_ref(x, k_cache, v_cache, wq, wo):
        B, Sq, D = x.shape
        Hq, Dh = (32, 192)
        Hkv = k_cache.shape[1]
        rep = Hq // Hkv
        q = (lambda x, *d: x.permute(*d))((x @ wq).reshape(B, Sq, Hq, Dh), 0, 2, 1, 3)
        k = (lambda x, n, axis: torch.repeat_interleave(x, n, dim=axis))(k_cache, rep, axis=1)
        v = (lambda x, n, axis: torch.repeat_interleave(x, n, dim=axis))(v_cache, rep, axis=1)
        scores = torch.einsum('bhqd,bhkd->bhqk', q, k) * Dh ** (-0.5)
        p = _softmax(scores, axis=-1)
        o = torch.einsum('bhqk,bhkd->bhqd', p, v)
        return (lambda x, *d: x.permute(*d))(o, 0, 2, 1, 3).reshape(B, Sq, Hq * Dh) @ wo

    def _B_ref(x, w_gate, w_up, w_down):
        return _gelu(x @ w_gate) * (x @ w_up) @ w_down
    x = A_x
    mod = (_silu(c) @ w_mod).reshape(c.shape[0], 6, 1, -1)
    sa, ca, ga, sb, cb, gb = (mod[:, 0].clone(), mod[:, 1].clone(), mod[:, 2].clone(), mod[:, 3].clone(), mod[:, 4].clone(), mod[:, 5].clone())
    h = _layernorm(x, axis=-1) * (1 + ca) + sa
    x = x + ga * _A_ref(h, A_k_cache, A_v_cache, A_wq, A_wo)
    h = _layernorm(x, axis=-1) * (1 + cb) + sb
    x = x + gb * _B_ref(h, B_w_gate, B_w_up, B_w_down)
    return x
```

```asm
; @launch grid=(256,1,1) block=(512,1,1) lds=146432
.amdgcn_target "amdgcn-amd-amdhsa--gfx950"
.text
.globl adaLN_cond__gqa_block_cached__geglu_ffn__decode_kernel
.p2align 8
.type adaLN_cond__gqa_block_cached__geglu_ffn__decode_kernel,@function
adaLN_cond__gqa_block_cached__geglu_ffn__decode_kernel:
    s_cmp_ge_u32 s2, 256
    s_cbranch_scc1 L_exit
    s_load_dwordx16 s[16:31], s[0:1], 0
    s_load_dwordx8 s[32:39], s[0:1], 64
    s_load_dwordx4 s[40:43], s[0:1], 96
    v_lshrrev_b32 v2, 6, v0
    v_and_b32 v1, 63, v0
    v_readfirstlane_b32 s3, v2
    v_mov_b32 v14, 146304
    v_mov_b32 v4, 0
    v_mov_b32 v5, 0
    v_mov_b32 v6, 0
    v_mov_b32 v7, 0
    s_cmp_lg_u32 s3, 0
    s_cbranch_scc1 L_nflag
    ds_write_b128 v14, v[4:7]
    ds_write_b128 v14, v[4:7] offset:16
    ds_write_b128 v14, v[4:7] offset:32
L_nflag:
    s_and_b32 s74, s2, 7
    s_lshr_b32 s6, s2, 5
    s_bfe_u32 s73, s2, 0x20003
    s_lshl_b32 s5, s74, 2
    s_add_u32 s5, s5, s73
    s_mov_b32 s52, 2097152
    s_mov_b32 s53, 0xffff0000
    s_mov_b32 s54, 0x3d93cd3a
    s_mov_b32 s55, 0x3fb8aa3b
    v_and_b32 v2, 15, v1
    v_lshrrev_b32 v3, 4, v1
    v_mov_b32 v11, 0
    s_waitcnt lgkmcnt(0)
    s_load_dword s4, s[42:43], 0
    s_and_b32 s41, s6, 3
    s_mov_b32 s26, 0x3f803f80
    s_mov_b64 s[0:1], -1
    s_mov_b32 s44, s42
    s_mov_b32 s45, s43
    s_mov_b32 s46, 6291456
    s_mov_b32 s47, 0x20000
    s_barrier
    s_cmp_lt_u32 s3, 4
    s_cbranch_scc1 L_stream
    s_cmp_eq_u32 s3, 4
    s_cbranch_scc1 L_w4
    s_cmp_lt_u32 s3, 7
    s_cbranch_scc1 L_w56
    s_branch L_w7
L_timeout:
    s_mov_b64 exec, -1
L_exit:
    s_endpgm
L_stream:
    s_mul_i32 s7, s5, 1572864
    s_add_u32 s8, s18, s7
    s_addc_u32 s9, s19, 0
    s_mov_b32 s10, 152567808
    s_mov_b32 s11, 0x20000
    s_add_u32 s12, s20, s7
    s_addc_u32 s13, s21, 0
    s_mov_b32 s14, 152567808
    s_mov_b32 s15, 0x20000
    s_lshl_b32 s24, s6, 2
    s_add_u32 s24, s24, s3
    s_mul_i32 s56, s24, 3072
    s_mul_i32 s7, s5, 7
    s_and_b32 s7, s7, 15
    s_mul_i32 s7, s7, 98304
    s_add_u32 s56, s56, s7
    s_mov_b32 s57, 0
    v_lshrrev_b32 v2, 3, v1
    v_mul_u32_u24 v12, 384, v2
    v_and_b32 v3, 7, v1
    v_lshl_add_u32 v12, v3, 4, v12
    s_barrier
    s_add_u32 s24, s56, s57
    buffer_load_dwordx4 v[64:67], v12, s[8:11], s24 offen offset:0 nt
    buffer_load_dwordx4 v[68:71], v12, s[8:11], s24 offen offset:128 nt
    buffer_load_dwordx4 v[72:75], v12, s[8:11], s24 offen offset:256 nt
    s_add_u32 s56, s56, 98304
    s_sub_u32 s7, s56, 1572864
    s_cselect_b32 s56, s56, s7
    s_add_u32 s24, s56, s57
    buffer_load_dwordx4 v[76:79], v12, s[8:11], s24 offen offset:0 nt
    buffer_load_dwordx4 v[80:83], v12, s[8:11], s24 offen offset:128 nt
    buffer_load_dwordx4 v[84:87], v12, s[8:11], s24 offen offset:256 nt
    s_add_u32 s56, s56, 98304
    s_sub_u32 s7, s56, 1572864
    s_cselect_b32 s56, s56, s7
    s_add_u32 s24, s56, s57
    buffer_load_dwordx4 v[88:91], v12, s[8:11], s24 offen offset:0 nt
    s_waitcnt lgkmcnt(0)
    s_add_u32 s4, s4, 1
    s_mov_b32 s75, s6
    s_lshl_b32 s78, s75, 2
    s_add_u32 s78, s78, s73
    s_lshl_b32 s68, s75, 5
    s_add_u32 s68, s68, s5
    s_sub_u32 s68, s68, 160
    s_cmp_ge_u32 s75, 5
    s_cselect_b32 s78, s68, s78
    s_lshl_b32 s79, s5, 2
    s_cmp_eq_u32 s75, 0
    s_cselect_b32 s79, s79, -1
    s_cmp_eq_u32 s74, 4
    s_cselect_b32 s68, 36, -1
    s_cmp_eq_u32 s74, 2
    s_cselect_b32 s68, 32, s68
    s_cmp_eq_u32 s75, 2
    s_cselect_b32 s68, s68, -1
    s_add_u32 s69, s68, s73
    s_lshl_b32 s69, s69, 2
    s_cmp_lg_u32 s68, -1
    s_cselect_b32 s79, s69, s79
    s_add_u32 s77, s5, 20
    s_cmp_eq_u32 s75, 1
    s_cselect_b32 s77, s77, -1
    s_cmp_eq_u32 s74, 6
    s_cselect_b32 s68, 56, -1
    s_cmp_eq_u32 s74, 0
    s_cselect_b32 s68, 52, s68
    s_cmp_eq_u32 s75, 3
    s_cselect_b32 s68, s68, -1
    s_add_u32 s69, s68, s73
    s_cmp_lg_u32 s68, -1
    s_cselect_b32 s77, s69, s77
    s_sub_u32 s68, s75, 4
    s_lshl_b32 s76, s68, 5
    s_add_u32 s76, s76, s5
    s_cmp_lt_u32 s76, 80
    s_cselect_b32 s76, s76, -1
    s_lshl_b32 s68, s75, 2
    s_lshr_b32 s72, 0x44411155, s68
    s_and_b32 s72, s72, 15
    s_cmp_lg_u32 s77, -1
    s_cselect_b32 s72, 5, s72
    s_cmp_lg_u32 s79, -1
    s_cselect_b32 s72, 5, s72
    v_and_b32 v4, 1, v1
    v_cmp_eq_u32 vcc, 1, v4
    v_mov_b32 v5, 0xffff
    v_mov_b32 v6, s53
    v_cndmask_b32 v5, v5, v6, vcc
    v_lshrrev_b32 v4, 1, v3
    v_cmp_eq_u32 vcc, 0, v4
    s_nop 1
    v_cndmask_b32 v56, 0, v5, vcc
    v_cmp_eq_u32 vcc, 1, v4
    s_nop 1
    v_cndmask_b32 v57, 0, v5, vcc
    v_cmp_eq_u32 vcc, 2, v4
    s_nop 1
    v_cndmask_b32 v58, 0, v5, vcc
    v_cmp_eq_u32 vcc, 3, v4
    s_nop 1
    v_cndmask_b32 v59, 0, v5, vcc
    v_lshrrev_b32 v4, 5, v1
    s_lshl_b32 s68, s3, 1
    v_add_u32 v13, s68, v4
    v_mul_u32_u24 v13, 768, v13
    v_lshl_add_u32 v13, v3, 5, v13
    v_and_b32 v5, 16, v1
    v_add_u32 v13, v13, v5
    v_mul_u32_u24 v4, 768, v4
    v_and_b32 v5, 31, v1
    v_mul_u32_u24 v5, 24, v5
    v_add_u32 v0, v4, v5
    v_add_u32 v0, 18432, v0
    v_lshlrev_b32 v11, 4, v3
    v_add_u32 v11, 144640, v11
    s_lshl_b32 s68, s3, 10
    s_add_u32 s68, s68, 24576
    v_lshl_add_u32 v3, v2, 5, s68
    v_lshlrev_b32 v2, 4, v1
    s_mov_b32 s35, 0x01000100
    s_mov_b32 s36, 0x03020302
    s_lshl_b32 s30, s5, 5
    s_add_u32 s30, s30, s6
    s_lshl_b32 s30, s30, 10
    s_add_u32 s30, s30, 4218880
    s_and_b32 s31, s4, 0xbfffbfff
    s_mov_b32 s32, 146176
    s_mov_b32 s33, 146336
    s_getreg_b32 s68, hwreg(HW_REG_XCC_ID, 0, 1)
    s_cmp_eq_u32 s68, 0
    s_cselect_b32 s68, 3, 0
    s_add_u32 s72, s72, s68
    s_mul_i32 s37, s72, 0x109c09c1
    s_mov_b32 s38, 0
    s_waitcnt vmcnt(6)
    buffer_load_dwordx4 v[92:95], v12, s[8:11], s24 offen offset:128 nt
    s_waitcnt vmcnt(6)
    buffer_load_dwordx4 v[96:99], v12, s[8:11], s24 offen offset:256 nt
    s_add_u32 s56, s56, 98304
    s_sub_u32 s7, s56, 1572864
    s_cselect_b32 s56, s56, s7
    s_add_u32 s24, s56, s57
    s_waitcnt vmcnt(6)
    buffer_load_dwordx4 v[100:103], v12, s[8:11], s24 offen offset:0 nt
    s_waitcnt vmcnt(6)
    buffer_load_dwordx4 v[104:107], v12, s[8:11], s24 offen offset:128 nt
    s_waitcnt vmcnt(6)
    buffer_load_dwordx4 v[108:111], v12, s[8:11], s24 offen offset:256 nt
    s_add_u32 s56, s56, 98304
    s_sub_u32 s7, s56, 1572864
    s_cselect_b32 s56, s56, s7
    s_add_u32 s24, s56, s57
    s_waitcnt vmcnt(6)
    buffer_load_dwordx4 v[112:115], v12, s[8:11], s24 offen offset:0 nt
    s_waitcnt vmcnt(6)
    buffer_load_dwordx4 v[116:119], v12, s[8:11], s24 offen offset:128 nt
    s_waitcnt vmcnt(6)
    buffer_load_dwordx4 v[120:123], v12, s[8:11], s24 offen offset:256 nt
    s_add_u32 s56, s56, 98304
    s_sub_u32 s7, s56, 1572864
    s_cselect_b32 s56, s56, s7
    s_add_u32 s24, s56, s57
    s_waitcnt vmcnt(6)
    buffer_load_dwordx4 v[124:127], v12, s[8:11], s24 offen offset:0 nt
    s_waitcnt vmcnt(6)
    buffer_load_dwordx4 v[128:131], v12, s[8:11], s24 offen offset:128 nt
    s_waitcnt vmcnt(6)
    buffer_load_dwordx4 v[132:135], v12, s[8:11], s24 offen offset:256 nt
    s_add_u32 s56, s56, 98304
    s_sub_u32 s7, s56, 1572864
    s_cselect_b32 s56, s56, s7
    s_add_u32 s24, s56, s57
    s_waitcnt vmcnt(6)
    buffer_load_dwordx4 v[136:139], v12, s[8:11], s24 offen offset:0 nt
    s_waitcnt vmcnt(6)
    buffer_load_dwordx4 v[140:143], v12, s[8:11], s24 offen offset:128 nt
    s_waitcnt vmcnt(6)
    buffer_load_dwordx4 v[144:147], v12, s[8:11], s24 offen offset:256 nt
    s_add_u32 s56, s56, 98304
    s_sub_u32 s7, s56, 1572864
    s_cselect_b32 s56, s56, s7
    s_add_u32 s24, s56, s57
    s_waitcnt vmcnt(6)
    buffer_load_dwordx4 v[148:151], v12, s[8:11], s24 offen offset:0 nt
    s_waitcnt vmcnt(6)
    buffer_load_dwordx4 v[152:155], v12, s[8:11], s24 offen offset:128 nt
    s_waitcnt vmcnt(6)
    buffer_load_dwordx4 v[156:159], v12, s[8:11], s24 offen offset:256 nt
    s_add_u32 s56, s56, 98304
    s_sub_u32 s7, s56, 1572864
    s_cselect_b32 s56, s56, s7
    s_add_u32 s24, s56, s57
    s_waitcnt vmcnt(6)
    buffer_load_dwordx4 v[160:163], v12, s[8:11], s24 offen offset:0 nt
    s_waitcnt vmcnt(6)
    buffer_load_dwordx4 v[164:167], v12, s[8:11], s24 offen offset:128 nt
    s_waitcnt vmcnt(6)
    buffer_load_dwordx4 v[168:171], v12, s[8:11], s24 offen offset:256 nt
    s_add_u32 s56, s56, 98304
    s_sub_u32 s7, s56, 1572864
    s_cselect_b32 s56, s56, s7
    s_add_u32 s24, s56, s57
    s_waitcnt vmcnt(6)
    buffer_load_dwordx4 v[172:175], v12, s[8:11], s24 offen offset:0 nt
    s_waitcnt vmcnt(6)
    buffer_load_dwordx4 v[176:179], v12, s[8:11], s24 offen offset:128 nt
    s_waitcnt vmcnt(6)
    buffer_load_dwordx4 v[180:183], v12, s[8:11], s24 offen offset:256 nt
    s_add_u32 s56, s56, 98304
    s_sub_u32 s7, s56, 1572864
    s_cselect_b32 s56, s56, s7
    s_add_u32 s24, s56, s57
    s_waitcnt vmcnt(6)
    buffer_load_dwordx4 v[184:187], v12, s[8:11], s24 offen offset:0 nt
    s_waitcnt vmcnt(6)
    buffer_load_dwordx4 v[188:191], v12, s[8:11], s24 offen offset:128 nt
    s_waitcnt vmcnt(6)
    buffer_load_dwordx4 v[192:195], v12, s[8:11], s24 offen offset:256 nt
    s_add_u32 s56, s56, 98304
    s_sub_u32 s7, s56, 1572864
    s_cselect_b32 s56, s56, s7
    s_add_u32 s24, s56, s57
    s_waitcnt vmcnt(6)
    buffer_load_dwordx4 v[196:199], v12, s[8:11], s24 offen offset:0 nt
    s_waitcnt vmcnt(6)
    buffer_load_dwordx4 v[200:203], v12, s[8:11], s24 offen offset:128 nt
    s_waitcnt vmcnt(6)
    buffer_load_dwordx4 v[204:207], v12, s[8:11], s24 offen offset:256 nt
    s_add_u32 s56, s56, 98304
    s_sub_u32 s7, s56, 1572864
    s_cselect_b32 s56, s56, s7
    s_add_u32 s24, s56, s57
    s_waitcnt vmcnt(6)
    buffer_load_dwordx4 v[208:211], v12, s[8:11], s24 offen offset:0 nt
    s_waitcnt vmcnt(6)
    buffer_load_dwordx4 v[212:215], v12, s[8:11], s24 offen offset:128 nt
    s_waitcnt vmcnt(6)
    buffer_load_dwordx4 v[216:219], v12, s[8:11], s24 offen offset:256 nt
    s_add_u32 s56, s56, 98304
    s_sub_u32 s7, s56, 1572864
    s_cselect_b32 s56, s56, s7
    s_add_u32 s24, s56, s57
    s_waitcnt vmcnt(6)
    buffer_load_dwordx4 v[220:223], v12, s[8:11], s24 offen offset:0 nt
    s_waitcnt vmcnt(6)
    buffer_load_dwordx4 v[224:227], v12, s[8:11], s24 offen offset:128 nt
    s_waitcnt vmcnt(6)
    buffer_load_dwordx4 v[228:231], v12, s[8:11], s24 offen offset:256 nt
    s_add_u32 s56, s56, 98304
    s_sub_u32 s7, s56, 1572864
    s_cselect_b32 s56, s56, s7
    s_add_u32 s24, s56, s57
    s_waitcnt vmcnt(6)
    buffer_load_dwordx4 v[232:235], v12, s[8:11], s24 offen offset:0 nt
    s_waitcnt vmcnt(6)
    buffer_load_dwordx4 v[236:239], v12, s[8:11], s24 offen offset:128 nt
    s_waitcnt vmcnt(6)
    buffer_load_dwordx4 v[240:243], v12, s[8:11], s24 offen offset:256 nt
    s_add_u32 s56, s56, 98304
    s_sub_u32 s7, s56, 1572864
    s_cselect_b32 s56, s56, s7
    s_add_u32 s24, s56, s57
    s_waitcnt vmcnt(6)
    buffer_load_dwordx4 v[244:247], v12, s[8:11], s24 offen offset:0 nt
    s_waitcnt vmcnt(6)
    buffer_load_dwordx4 v[248:251], v12, s[8:11], s24 offen offset:128 nt
    s_waitcnt vmcnt(6)
    buffer_load_dwordx4 v[252:255], v12, s[8:11], s24 offen offset:256 nt
    s_add_u32 s56, s56, 98304
    s_sub_u32 s7, s56, 1572864
    s_cselect_b32 s56, s56, s7
    s_mov_b64 exec, 1
    v_mov_b32 v15, 1
    ds_add_u32 v14, v15 offset:20
    s_mov_b64 exec, -1
    s_mov_b32 s58, 0
    s_mov_b32 s39, 0
L_lw_1:
    ds_read_b32 v15, v14 offset:4
    s_waitcnt lgkmcnt(0)
    v_readfirstlane_b32 s7, v15
    s_nop 0
    s_cmp_gt_u32 s7, s58
    s_cbranch_scc1 L_lwd_2
    s_sub_u32 s52, s52, 1
    s_cbranch_scc1 L_timeout
    s_sleep 1
    s_branch L_lw_1
L_lwd_2:
    ds_read_b128 v[16:19], v11 offset:0
    ds_read_b128 v[20:23], v11 offset:128
    ds_read_b128 v[24:27], v11 offset:256
    v_add_u32 v11, 384, v11
    s_add_u32 s58, s58, 1
    ds_read_b32 v5, v14 offset:0
    s_waitcnt lgkmcnt(0)
    v_readfirstlane_b32 s40, v5
    s_mov_b32 s25, 0
L_sloop:
    s_add_u32 s57, s57, 50331648
    s_cmp_eq_u32 s25, 3
    s_cselect_b32 s57, 0, s57
    s_cselect_b32 s8, s12, s8
    s_cselect_b32 s9, s13, s9
    s_waitcnt lgkmcnt(0)
    v_dot2_f32_bf16 v40, v64, v16, 0
    v_dot2_f32_bf16 v41, v76, v16, 0
    v_dot2_f32_bf16 v40, v65, v17, v40
    v_dot2_f32_bf16 v41, v77, v17, v41
    v_dot2_f32_bf16 v40, v66, v18, v40
    v_dot2_f32_bf16 v41, v78, v18, v41
    v_dot2_f32_bf16 v40, v67, v19, v40
    v_dot2_f32_bf16 v41, v79, v19, v41
    v_dot2_f32_bf16 v40, v68, v20, v40
    v_dot2_f32_bf16 v41, v80, v20, v41
    v_dot2_f32_bf16 v40, v69, v21, v40
    v_dot2_f32_bf16 v41, v81, v21, v41
    v_dot2_f32_bf16 v40, v70, v22, v40
    v_dot2_f32_bf16 v41, v82, v22, v41
    v_dot2_f32_bf16 v40, v71, v23, v40
    v_dot2_f32_bf16 v41, v83, v23, v41
    v_dot2_f32_bf16 v40, v72, v24, v40
    v_dot2_f32_bf16 v41, v84, v24, v41
    v_dot2_f32_bf16 v40, v73, v25, v40
    v_dot2_f32_bf16 v41, v85, v25, v41
    v_dot2_f32_bf16 v40, v74, v26, v40
    v_dot2_f32_bf16 v41, v86, v26, v41
    v_dot2_f32_bf16 v40, v75, v27, v40
    v_dot2_f32_bf16 v41, v87, v27, v41
    s_add_u32 s24, s56, s57
    s_add_u32 s38, s38, s37
    s_cselect_b64 vcc, -1, 0
    s_cbranch_vccnz L_np_3
    s_waitcnt vmcnt(4)
L_np_3:
    s_waitcnt vmcnt(5)
    buffer_load_dwordx4 v[64:67], v12, s[8:11], s24 offen offset:0 nt
    v_dot2_f32_bf16 v42, v88, v16, 0
    v_dot2_f32_bf16 v43, v100, v16, 0
    v_dot2_f32_bf16 v42, v89, v17, v42
    v_dot2_f32_bf16 v43, v101, v17, v43
    v_dot2_f32_bf16 v42, v90, v18, v42
    v_dot2_f32_bf16 v43, v102, v18, v43
    v_dot2_f32_bf16 v42, v91, v19, v42
    s_cbranch_vccnz L_np_4
    s_waitcnt vmcnt(4)
L_np_4:
    s_waitcnt vmcnt(5)
    buffer_load_dwordx4 v[68:71], v12, s[8:11], s24 offen offset:128 nt
    v_dot2_f32_bf16 v43, v103, v19, v43
    v_dot2_f32_bf16 v42, v92, v20, v42
    v_dot2_f32_bf16 v43, v104, v20, v43
    v_dot2_f32_bf16 v42, v93, v21, v42
    v_dot2_f32_bf16 v43, v105, v21, v43
    v_dot2_f32_bf16 v42, v94, v22, v42
    v_dot2_f32_bf16 v43, v106, v22, v43
    v_dot2_f32_bf16 v42, v95, v23, v42
    s_cbranch_vccnz L_np_5
    s_waitcnt vmcnt(4)
L_np_5:
    s_waitcnt vmcnt(5)
    buffer_load_dwordx4 v[72:75], v12, s[8:11], s24 offen offset:256 nt
    s_add_u32 s56, s56, 98304
    s_sub_u32 s7, s56, 1572864
    s_cselect_b32 s56, s56, s7
    v_dot2_f32_bf16 v43, v107, v23, v43
    v_dot2_f32_bf16 v42, v96, v24, v42
    v_dot2_f32_bf16 v43, v108, v24, v43
    v_dot2_f32_bf16 v42, v97, v25, v42
    v_dot2_f32_bf16 v43, v109, v25, v43
    v_dot2_f32_bf16 v42, v98, v26, v42
    v_dot2_f32_bf16 v43, v110, v26, v43
    v_dot2_f32_bf16 v42, v99, v27, v42
    s_add_u32 s24, s56, s57
    s_add_u32 s38, s38, s37
    s_cselect_b64 vcc, -1, 0
    s_cbranch_vccnz L_np_6
    s_waitcnt vmcnt(4)
L_np_6:
    s_waitcnt vmcnt(5)
    buffer_load_dwordx4 v[76:79], v12, s[8:11], s24 offen offset:0 nt
    v_dot2_f32_bf16 v43, v111, v27, v43
    v_dot2_f32_bf16 v44, v112, v16, 0
    v_dot2_f32_bf16 v45, v124, v16, 0
    v_dot2_f32_bf16 v44, v113, v17, v44
    v_dot2_f32_bf16 v45, v125, v17, v45
    v_dot2_f32_bf16 v44, v114, v18, v44
    v_dot2_f32_bf16 v45, v126, v18, v45
    s_cbranch_vccnz L_np_7
    s_waitcnt vmcnt(4)
L_np_7:
    s_waitcnt vmcnt(5)
    buffer_load_dwordx4 v[80:83], v12, s[8:11], s24 offen offset:128 nt
    v_dot2_f32_bf16 v44, v115, v19, v44
    v_dot2_f32_bf16 v45, v127, v19, v45
    v_dot2_f32_bf16 v44, v116, v20, v44
    v_dot2_f32_bf16 v45, v128, v20, v45
    v_dot2_f32_bf16 v44, v117, v21, v44
    v_dot2_f32_bf16 v45, v129, v21, v45
    v_dot2_f32_bf16 v44, v118, v22, v44
    v_dot2_f32_bf16 v45, v130, v22, v45
    s_cbranch_vccnz L_np_8
    s_waitcnt vmcnt(4)
L_np_8:
    s_waitcnt vmcnt(5)
    buffer_load_dwordx4 v[84:87], v12, s[8:11], s24 offen offset:256 nt
    s_add_u32 s56, s56, 98304
    s_sub_u32 s7, s56, 1572864
    s_cselect_b32 s56, s56, s7
    s_add_u32 s39, s39, 1
    v_mov_b32 v8, s39
    ds_write_b32 v14, v8 offset:24
    v_dot2_f32_bf16 v44, v119, v23, v44
    v_dot2_f32_bf16 v45, v131, v23, v45
    v_dot2_f32_bf16 v44, v120, v24, v44
    v_dot2_f32_bf16 v45, v132, v24, v45
    v_dot2_f32_bf16 v44, v121, v25, v44
    v_dot2_f32_bf16 v45, v133, v25, v45
    v_dot2_f32_bf16 v44, v122, v26, v44
    v_dot2_f32_bf16 v45, v134, v26, v45
    s_add_u32 s24, s56, s57
    s_add_u32 s38, s38, s37
    s_cselect_b64 vcc, -1, 0
    s_cbranch_vccnz L_np_9
    s_waitcnt vmcnt(4)
L_np_9:
    s_waitcnt vmcnt(5)
    buffer_load_dwordx4 v[88:91], v12, s[8:11], s24 offen offset:0 nt
    v_dot2_f32_bf16 v44, v123, v27, v44
    v_dot2_f32_bf16 v45, v135, v27, v45
    v_dot2_f32_bf16 v46, v136, v16, 0
    v_dot2_f32_bf16 v47, v148, v16, 0
    v_dot2_f32_bf16 v46, v137, v17, v46
    v_dot2_f32_bf16 v47, v149, v17, v47
    v_dot2_f32_bf16 v46, v138, v18, v46
    s_cbranch_vccnz L_np_10
    s_waitcnt vmcnt(4)
L_np_10:
    s_waitcnt vmcnt(5)
    buffer_load_dwordx4 v[92:95], v12, s[8:11], s24 offen offset:128 nt
    v_dot2_f32_bf16 v47, v150, v18, v47
    v_dot2_f32_bf16 v46, v139, v19, v46
    v_dot2_f32_bf16 v47, v151, v19, v47
    v_dot2_f32_bf16 v46, v140, v20, v46
    v_dot2_f32_bf16 v47, v152, v20, v47
    v_dot2_f32_bf16 v46, v141, v21, v46
    v_dot2_f32_bf16 v47, v153, v21, v47
    v_dot2_f32_bf16 v46, v142, v22, v46
    s_cbranch_vccnz L_np_11
    s_waitcnt vmcnt(4)
L_np_11:
    s_waitcnt vmcnt(5)
    buffer_load_dwordx4 v[96:99], v12, s[8:11], s24 offen offset:256 nt
    s_add_u32 s56, s56, 98304
    s_sub_u32 s7, s56, 1572864
    s_cselect_b32 s56, s56, s7
    v_dot2_f32_bf16 v47, v154, v22, v47
    v_dot2_f32_bf16 v46, v143, v23, v46
    v_dot2_f32_bf16 v47, v155, v23, v47
    v_dot2_f32_bf16 v46, v144, v24, v46
    v_dot2_f32_bf16 v47, v156, v24, v47
    v_dot2_f32_bf16 v46, v145, v25, v46
    v_dot2_f32_bf16 v47, v157, v25, v47
    v_dot2_f32_bf16 v46, v146, v26, v46
    s_add_u32 s24, s56, s57
    s_add_u32 s38, s38, s37
    s_cselect_b64 vcc, -1, 0
    s_cbranch_vccnz L_np_12
    s_waitcnt vmcnt(4)
L_np_12:
    s_waitcnt vmcnt(5)
    buffer_load_dwordx4 v[100:103], v12, s[8:11], s24 offen offset:0 nt
    v_dot2_f32_bf16 v47, v158, v26, v47
    v_dot2_f32_bf16 v46, v147, v27, v46
    v_dot2_f32_bf16 v47, v159, v27, v47
    v_dot2_f32_bf16 v48, v160, v16, 0
    v_dot2_f32_bf16 v49, v172, v16, 0
    v_dot2_f32_bf16 v48, v161, v17, v48
    v_dot2_f32_bf16 v49, v173, v17, v49
    s_cbranch_vccnz L_np_13
    s_waitcnt vmcnt(4)
L_np_13:
    s_waitcnt vmcnt(5)
    buffer_load_dwordx4 v[104:107], v12, s[8:11], s24 offen offset:128 nt
    v_dot2_f32_bf16 v48, v162, v18, v48
    v_dot2_f32_bf16 v49, v174, v18, v49
    v_dot2_f32_bf16 v48, v163, v19, v48
    v_dot2_f32_bf16 v49, v175, v19, v49
    v_dot2_f32_bf16 v48, v164, v20, v48
    v_dot2_f32_bf16 v49, v176, v20, v49
    v_dot2_f32_bf16 v48, v165, v21, v48
    v_dot2_f32_bf16 v49, v177, v21, v49
    s_cbranch_vccnz L_np_14
    s_waitcnt vmcnt(4)
L_np_14:
    s_waitcnt vmcnt(5)
    buffer_load_dwordx4 v[108:111], v12, s[8:11], s24 offen offset:256 nt
    s_add_u32 s56, s56, 98304
    s_sub_u32 s7, s56, 1572864
    s_cselect_b32 s56, s56, s7
    s_add_u32 s39, s39, 1
    v_mov_b32 v8, s39
    ds_write_b32 v14, v8 offset:24
    v_dot2_f32_bf16 v48, v166, v22, v48
    v_dot2_f32_bf16 v49, v178, v22, v49
    v_dot2_f32_bf16 v48, v167, v23, v48
    v_dot2_f32_bf16 v49, v179, v23, v49
    v_dot2_f32_bf16 v48, v168, v24, v48
    v_dot2_f32_bf16 v49, v180, v24, v49
    v_dot2_f32_bf16 v48, v169, v25, v48
    v_dot2_f32_bf16 v49, v181, v25, v49
    s_add_u32 s24, s56, s57
    s_add_u32 s38, s38, s37
    s_cselect_b64 vcc, -1, 0
    s_cbranch_vccnz L_np_15
    s_waitcnt vmcnt(4)
L_np_15:
    s_waitcnt vmcnt(5)
    buffer_load_dwordx4 v[112:115], v12, s[8:11], s24 offen offset:0 nt
    v_dot2_f32_bf16 v48, v170, v26, v48
    v_dot2_f32_bf16 v49, v182, v26, v49
    v_dot2_f32_bf16 v48, v171, v27, v48
    v_dot2_f32_bf16 v49, v183, v27, v49
    v_dot2_f32_bf16 v50, v184, v16, 0
    v_dot2_f32_bf16 v51, v196, v16, 0
    v_dot2_f32_bf16 v50, v185, v17, v50
    s_cbranch_vccnz L_np_16
    s_waitcnt vmcnt(4)
L_np_16:
    s_waitcnt vmcnt(5)
    buffer_load_dwordx4 v[116:119], v12, s[8:11], s24 offen offset:128 nt
    v_dot2_f32_bf16 v51, v197, v17, v51
    v_dot2_f32_bf16 v50, v186, v18, v50
    v_dot2_f32_bf16 v51, v198, v18, v51
    v_dot2_f32_bf16 v50, v187, v19, v50
    v_dot2_f32_bf16 v51, v199, v19, v51
    v_dot2_f32_bf16 v50, v188, v20, v50
    v_dot2_f32_bf16 v51, v200, v20, v51
    v_dot2_f32_bf16 v50, v189, v21, v50
    s_cbranch_vccnz L_np_17
    s_waitcnt vmcnt(4)
L_np_17:
    s_waitcnt vmcnt(5)
    buffer_load_dwordx4 v[120:123], v12, s[8:11], s24 offen offset:256 nt
    s_add_u32 s56, s56, 98304
    s_sub_u32 s7, s56, 1572864
    s_cselect_b32 s56, s56, s7
    v_dot2_f32_bf16 v51, v201, v21, v51
    v_dot2_f32_bf16 v50, v190, v22, v50
    v_dot2_f32_bf16 v51, v202, v22, v51
    v_dot2_f32_bf16 v50, v191, v23, v50
    v_dot2_f32_bf16 v51, v203, v23, v51
    v_dot2_f32_bf16 v50, v192, v24, v50
    v_dot2_f32_bf16 v51, v204, v24, v51
    v_dot2_f32_bf16 v50, v193, v25, v50
    s_add_u32 s24, s56, s57
    s_add_u32 s38, s38, s37
    s_cselect_b64 vcc, -1, 0
    s_cbranch_vccnz L_np_18
    s_waitcnt vmcnt(4)
L_np_18:
    s_waitcnt vmcnt(5)
    buffer_load_dwordx4 v[124:127], v12, s[8:11], s24 offen offset:0 nt
    v_dot2_f32_bf16 v51, v205, v25, v51
    v_dot2_f32_bf16 v50, v194, v26, v50
    v_dot2_f32_bf16 v51, v206, v26, v51
    v_dot2_f32_bf16 v50, v195, v27, v50
    v_dot2_f32_bf16 v51, v207, v27, v51
    v_dot2_f32_bf16 v52, v208, v16, 0
    v_dot2_f32_bf16 v53, v220, v16, 0
    v_dot2_f32_bf16 v52, v209, v17, v52
    s_cbranch_vccnz L_np_19
    s_waitcnt vmcnt(4)
L_np_19:
    s_waitcnt vmcnt(5)
    buffer_load_dwordx4 v[128:131], v12, s[8:11], s24 offen offset:128 nt
    v_dot2_f32_bf16 v53, v221, v17, v53
    v_dot2_f32_bf16 v52, v210, v18, v52
    v_dot2_f32_bf16 v53, v222, v18, v53
    v_dot2_f32_bf16 v52, v211, v19, v52
    v_dot2_f32_bf16 v53, v223, v19, v53
    v_dot2_f32_bf16 v52, v212, v20, v52
    v_dot2_f32_bf16 v53, v224, v20, v53
    s_cbranch_vccnz L_np_20
    s_waitcnt vmcnt(4)
L_np_20:
    s_waitcnt vmcnt(5)
    buffer_load_dwordx4 v[132:135], v12, s[8:11], s24 offen offset:256 nt
    s_add_u32 s56, s56, 98304
    s_sub_u32 s7, s56, 1572864
    s_cselect_b32 s56, s56, s7
    s_add_u32 s39, s39, 1
    v_mov_b32 v8, s39
    ds_write_b32 v14, v8 offset:24
    v_dot2_f32_bf16 v52, v213, v21, v52
    v_dot2_f32_bf16 v53, v225, v21, v53
    v_dot2_f32_bf16 v52, v214, v22, v52
    v_dot2_f32_bf16 v53, v226, v22, v53
    v_dot2_f32_bf16 v52, v215, v23, v52
    v_dot2_f32_bf16 v53, v227, v23, v53
    v_dot2_f32_bf16 v52, v216, v24, v52
    v_dot2_f32_bf16 v53, v228, v24, v53
    s_add_u32 s24, s56, s57
    s_add_u32 s38, s38, s37
    s_cselect_b64 vcc, -1, 0
    s_cbranch_vccnz L_np_21
    s_waitcnt vmcnt(4)
L_np_21:
    s_waitcnt vmcnt(5)
    buffer_load_dwordx4 v[136:139], v12, s[8:11], s24 offen offset:0 nt
    v_dot2_f32_bf16 v52, v217, v25, v52
    v_dot2_f32_bf16 v53, v229, v25, v53
    v_dot2_f32_bf16 v52, v218, v26, v52
    v_dot2_f32_bf16 v53, v230, v26, v53
    v_dot2_f32_bf16 v52, v219, v27, v52
    v_dot2_f32_bf16 v53, v231, v27, v53
    v_dot2_f32_bf16 v54, v232, v16, 0
    v_dot2_f32_bf16 v55, v244, v16, 0
    s_cbranch_vccnz L_np_22
    s_waitcnt vmcnt(4)
L_np_22:
    s_waitcnt vmcnt(5)
    buffer_load_dwordx4 v[140:143], v12, s[8:11], s24 offen offset:128 nt
    v_dot2_f32_bf16 v54, v233, v17, v54
    v_dot2_f32_bf16 v55, v245, v17, v55
    v_dot2_f32_bf16 v54, v234, v18, v54
    v_dot2_f32_bf16 v55, v246, v18, v55
    v_dot2_f32_bf16 v54, v235, v19, v54
    v_dot2_f32_bf16 v55, v247, v19, v55
    v_dot2_f32_bf16 v54, v236, v20, v54
    s_cbranch_vccnz L_np_23
    s_waitcnt vmcnt(4)
L_np_23:
    s_waitcnt vmcnt(5)
    buffer_load_dwordx4 v[144:147], v12, s[8:11], s24 offen offset:256 nt
    s_add_u32 s56, s56, 98304
    s_sub_u32 s7, s56, 1572864
    s_cselect_b32 s56, s56, s7
    v_dot2_f32_bf16 v55, v248, v20, v55
    v_dot2_f32_bf16 v54, v237, v21, v54
    v_dot2_f32_bf16 v55, v249, v21, v55
    v_dot2_f32_bf16 v54, v238, v22, v54
    v_dot2_f32_bf16 v55, v250, v22, v55
    v_dot2_f32_bf16 v54, v239, v23, v54
    v_dot2_f32_bf16 v55, v251, v23, v55
    v_dot2_f32_bf16 v54, v240, v24, v54
    s_add_u32 s24, s56, s57
    s_add_u32 s38, s38, s37
    s_cselect_b64 vcc, -1, 0
    s_cbranch_vccnz L_np_24
    s_waitcnt vmcnt(4)
L_np_24:
    s_waitcnt vmcnt(5)
    buffer_load_dwordx4 v[148:151], v12, s[8:11], s24 offen offset:0 nt
    v_dot2_f32_bf16 v55, v252, v24, v55
    v_dot2_f32_bf16 v54, v241, v25, v54
    v_dot2_f32_bf16 v55, v253, v25, v55
    v_dot2_f32_bf16 v54, v242, v26, v54
    v_dot2_f32_bf16 v55, v254, v26, v55
    v_dot2_f32_bf16 v54, v243, v27, v54
    v_dot2_f32_bf16 v55, v255, v27, v55
    s_cmp_eq_u32 s58, 4
    s_cbranch_scc1 L_nq_25
L_lw_26:
    ds_read_b32 v15, v14 offset:4
    s_waitcnt lgkmcnt(0)
    v_readfirstlane_b32 s7, v15
    s_nop 0
    s_cmp_gt_u32 s7, s58
    s_cbranch_scc1 L_lwd_27
    s_sub_u32 s52, s52, 1
    s_cbranch_scc1 L_timeout
    s_sleep 1
    s_branch L_lw_26
L_lwd_27:
    ds_read_b128 v[16:19], v11 offset:0
    ds_read_b128 v[20:23], v11 offset:128
    ds_read_b128 v[24:27], v11 offset:256
    v_add_u32 v11, 384, v11
    s_add_u32 s58, s58, 1
L_nq_25:
    s_cbranch_vccnz L_np_28
    s_waitcnt vmcnt(4)
L_np_28:
    s_waitcnt vmcnt(5)
    buffer_load_dwordx4 v[152:155], v12, s[8:11], s24 offen offset:128 nt
    v_add_f32_dpp v40, v40, v40 quad_perm:[1,0,3,2] row_mask:0xf bank_mask:0xf
    v_add_f32_dpp v41, v41, v41 quad_perm:[1,0,3,2] row_mask:0xf bank_mask:0xf
    v_add_f32_dpp v42, v42, v42 quad_perm:[1,0,3,2] row_mask:0xf bank_mask:0xf
    v_add_f32_dpp v43, v43, v43 quad_perm:[1,0,3,2] row_mask:0xf bank_mask:0xf
    v_add_f32_dpp v44, v44, v44 quad_perm:[1,0,3,2] row_mask:0xf bank_mask:0xf
    v_add_f32_dpp v45, v45, v45 quad_perm:[1,0,3,2] row_mask:0xf bank_mask:0xf
    v_add_f32_dpp v46, v46, v46 quad_perm:[1,0,3,2] row_mask:0xf bank_mask:0xf
    s_cbranch_vccnz L_np_29
    s_waitcnt vmcnt(4)
L_np_29:
    s_waitcnt vmcnt(5)
    buffer_load_dwordx4 v[156:159], v12, s[8:11], s24 offen offset:256 nt
    s_add_u32 s56, s56, 98304
    s_sub_u32 s7, s56, 1572864
    s_cselect_b32 s56, s56, s7
    s_add_u32 s39, s39, 1
    v_mov_b32 v8, s39
    ds_write_b32 v14, v8 offset:24
    v_add_f32_dpp v47, v47, v47 quad_perm:[1,0,3,2] row_mask:0xf bank_mask:0xf
    v_add_f32_dpp v48, v48, v48 quad_perm:[1,0,3,2] row_mask:0xf bank_mask:0xf
    v_add_f32_dpp v49, v49, v49 quad_perm:[1,0,3,2] row_mask:0xf bank_mask:0xf
    v_add_f32_dpp v50, v50, v50 quad_perm:[1,0,3,2] row_mask:0xf bank_mask:0xf
    v_add_f32_dpp v51, v51, v51 quad_perm:[1,0,3,2] row_mask:0xf bank_mask:0xf
    v_add_f32_dpp v52, v52, v52 quad_perm:[1,0,3,2] row_mask:0xf bank_mask:0xf
    v_add_f32_dpp v53, v53, v53 quad_perm:[1,0,3,2] row_mask:0xf bank_mask:0xf
    v_add_f32_dpp v54, v54, v54 quad_perm:[1,0,3,2] row_mask:0xf bank_mask:0xf
    s_add_u32 s24, s56, s57
    s_add_u32 s38, s38, s37
    s_cselect_b64 vcc, -1, 0
    s_cbranch_vccnz L_np_30
    s_waitcnt vmcnt(4)
L_np_30:
    s_waitcnt vmcnt(5)
    buffer_load_dwordx4 v[160:163], v12, s[8:11], s24 offen offset:0 nt
    v_add_f32_dpp v55, v55, v55 quad_perm:[1,0,3,2] row_mask:0xf bank_mask:0xf
    v_add_f32_dpp v40, v40, v40 quad_perm:[2,3,0,1] row_mask:0xf bank_mask:0xf
    v_add_f32_dpp v41, v41, v41 quad_perm:[2,3,0,1] row_mask:0xf bank_mask:0xf
    v_add_f32_dpp v42, v42, v42 quad_perm:[2,3,0,1] row_mask:0xf bank_mask:0xf
    v_add_f32_dpp v43, v43, v43 quad_perm:[2,3,0,1] row_mask:0xf bank_mask:0xf
    v_add_f32_dpp v44, v44, v44 quad_perm:[2,3,0,1] row_mask:0xf bank_mask:0xf
    v_add_f32_dpp v45, v45, v45 quad_perm:[2,3,0,1] row_mask:0xf bank_mask:0xf
    v_add_f32_dpp v46, v46, v46 quad_perm:[2,3,0,1] row_mask:0xf bank_mask:0xf
    s_cbranch_vccnz L_np_31
    s_waitcnt vmcnt(4)
L_np_31:
    s_waitcnt vmcnt(5)
    buffer_load_dwordx4 v[164:167], v12, s[8:11], s24 offen offset:128 nt
    v_add_f32_dpp v47, v47, v47 quad_perm:[2,3,0,1] row_mask:0xf bank_mask:0xf
    v_add_f32_dpp v48, v48, v48 quad_perm:[2,3,0,1] row_mask:0xf bank_mask:0xf
    v_add_f32_dpp v49, v49, v49 quad_perm:[2,3,0,1] row_mask:0xf bank_mask:0xf
    v_add_f32_dpp v50, v50, v50 quad_perm:[2,3,0,1] row_mask:0xf bank_mask:0xf
    v_add_f32_dpp v51, v51, v51 quad_perm:[2,3,0,1] row_mask:0xf bank_mask:0xf
    v_add_f32_dpp v52, v52, v52 quad_perm:[2,3,0,1] row_mask:0xf bank_mask:0xf
    v_add_f32_dpp v53, v53, v53 quad_perm:[2,3,0,1] row_mask:0xf bank_mask:0xf
    s_cbranch_vccnz L_np_32
    s_waitcnt vmcnt(4)
L_np_32:
    s_waitcnt vmcnt(5)
    buffer_load_dwordx4 v[168:171], v12, s[8:11], s24 offen offset:256 nt
    s_add_u32 s56, s56, 98304
    s_sub_u32 s7, s56, 1572864
    s_cselect_b32 s56, s56, s7
    v_add_f32_dpp v54, v54, v54 quad_perm:[2,3,0,1] row_mask:0xf bank_mask:0xf
    v_add_f32_dpp v55, v55, v55 quad_perm:[2,3,0,1] row_mask:0xf bank_mask:0xf
    v_add_f32_dpp v40, v40, v40 row_half_mirror row_mask:0xf bank_mask:0xf
    v_add_f32_dpp v41, v41, v41 row_half_mirror row_mask:0xf bank_mask:0xf
    v_add_f32_dpp v42, v42, v42 row_half_mirror row_mask:0xf bank_mask:0xf
    v_add_f32_dpp v43, v43, v43 row_half_mirror row_mask:0xf bank_mask:0xf
    v_add_f32_dpp v44, v44, v44 row_half_mirror row_mask:0xf bank_mask:0xf
    v_add_f32_dpp v45, v45, v45 row_half_mirror row_mask:0xf bank_mask:0xf
    s_add_u32 s24, s56, s57
    s_add_u32 s38, s38, s37
    s_cselect_b64 vcc, -1, 0
    s_cbranch_vccnz L_np_33
    s_waitcnt vmcnt(4)
L_np_33:
    s_waitcnt vmcnt(5)
    buffer_load_dwordx4 v[172:175], v12, s[8:11], s24 offen offset:0 nt
    v_add_f32_dpp v46, v46, v46 row_half_mirror row_mask:0xf bank_mask:0xf
    v_add_f32_dpp v47, v47, v47 row_half_mirror row_mask:0xf bank_mask:0xf
    v_add_f32_dpp v48, v48, v48 row_half_mirror row_mask:0xf bank_mask:0xf
    v_add_f32_dpp v49, v49, v49 row_half_mirror row_mask:0xf bank_mask:0xf
    v_add_f32_dpp v50, v50, v50 row_half_mirror row_mask:0xf bank_mask:0xf
    v_add_f32_dpp v51, v51, v51 row_half_mirror row_mask:0xf bank_mask:0xf
    v_add_f32_dpp v52, v52, v52 row_half_mirror row_mask:0xf bank_mask:0xf
    v_add_f32_dpp v53, v53, v53 row_half_mirror row_mask:0xf bank_mask:0xf
    s_cbranch_vccnz L_np_34
    s_waitcnt vmcnt(4)
L_np_34:
    s_waitcnt vmcnt(5)
    buffer_load_dwordx4 v[176:179], v12, s[8:11], s24 offen offset:128 nt
    v_add_f32_dpp v54, v54, v54 row_half_mirror row_mask:0xf bank_mask:0xf
    v_add_f32_dpp v55, v55, v55 row_half_mirror row_mask:0xf bank_mask:0xf
    v_cvt_pk_bf16_f32 v4, v40, v41
    v_cvt_pk_bf16_f32 v5, v42, v43
    v_cvt_pk_bf16_f32 v6, v44, v45
    v_cvt_pk_bf16_f32 v7, v46, v47
    v_lshlrev_b32 v40, 16, v4
    s_cbranch_vccnz L_np_35
    s_waitcnt vmcnt(4)
L_np_35:
    s_waitcnt vmcnt(5)
    buffer_load_dwordx4 v[180:183], v12, s[8:11], s24 offen offset:256 nt
    s_add_u32 s56, s56, 98304
    s_sub_u32 s7, s56, 1572864
    s_cselect_b32 s56, s56, s7
    s_add_u32 s39, s39, 1
    v_mov_b32 v8, s39
    ds_write_b32 v14, v8 offset:24
    v_and_b32 v41, s53, v4
    v_lshlrev_b32 v42, 16, v5
    v_and_b32 v43, s53, v5
    v_lshlrev_b32 v44, 16, v6
    v_and_b32 v45, s53, v6
    v_lshlrev_b32 v46, 16, v7
    v_and_b32 v47, s53, v7
    v_mul_f32 v40, s54, v40
    s_add_u32 s24, s56, s57
    s_add_u32 s38, s38, s37
    s_cselect_b64 vcc, -1, 0
    s_cbranch_vccnz L_np_36
    s_waitcnt vmcnt(4)
L_np_36:
    s_waitcnt vmcnt(5)
    buffer_load_dwordx4 v[184:187], v12, s[8:11], s24 offen offset:0 nt
    v_mul_f32 v41, s54, v41
    v_mul_f32 v42, s54, v42
    v_mul_f32 v43, s54, v43
    v_mul_f32 v44, s54, v44
    v_mul_f32 v45, s54, v45
    v_mul_f32 v46, s54, v46
    v_mul_f32 v47, s54, v47
    v_cvt_pk_bf16_f32 v4, v40, v41
    s_cbranch_vccnz L_np_37
    s_waitcnt vmcnt(4)
L_np_37:
    s_waitcnt vmcnt(5)
    buffer_load_dwordx4 v[188:191], v12, s[8:11], s24 offen offset:128 nt
    v_cvt_pk_bf16_f32 v5, v42, v43
    v_cvt_pk_bf16_f32 v6, v44, v45
    v_cvt_pk_bf16_f32 v7, v46, v47
    v_lshlrev_b32 v40, 16, v4
    v_and_b32 v41, s53, v4
    v_lshlrev_b32 v42, 16, v5
    v_and_b32 v43, s53, v5
    v_lshlrev_b32 v44, 16, v6
    s_cbranch_vccnz L_np_38
    s_waitcnt vmcnt(4)
L_np_38:
    s_waitcnt vmcnt(5)
    buffer_load_dwordx4 v[192:195], v12, s[8:11], s24 offen offset:256 nt
    s_add_u32 s56, s56, 98304
    s_sub_u32 s7, s56, 1572864
    s_cselect_b32 s56, s56, s7
    v_and_b32 v45, s53, v6
    v_lshlrev_b32 v46, 16, v7
    v_and_b32 v47, s53, v7
    v_cvt_pk_bf16_f32 v4, v48, v49
    v_cvt_pk_bf16_f32 v5, v50, v51
    v_cvt_pk_bf16_f32 v6, v52, v53
    v_cvt_pk_bf16_f32 v7, v54, v55
    s_add_u32 s24, s56, s57
    s_add_u32 s38, s38, s37
    s_cselect_b64 vcc, -1, 0
    s_cbranch_vccnz L_np_39
    s_waitcnt vmcnt(4)
L_np_39:
    s_waitcnt vmcnt(5)
    buffer_load_dwordx4 v[196:199], v12, s[8:11], s24 offen offset:0 nt
    v_lshlrev_b32 v48, 16, v4
    v_and_b32 v49, s53, v4
    v_lshlrev_b32 v50, 16, v5
    v_and_b32 v51, s53, v5
    v_lshlrev_b32 v52, 16, v6
    v_and_b32 v53, s53, v6
    v_lshlrev_b32 v54, 16, v7
    v_and_b32 v55, s53, v7
    s_cbranch_vccnz L_np_40
    s_waitcnt vmcnt(4)
L_np_40:
    s_waitcnt vmcnt(5)
    buffer_load_dwordx4 v[200:203], v12, s[8:11], s24 offen offset:128 nt
    v_mul_f32 v48, s54, v48
    v_mul_f32 v49, s54, v49
    v_mul_f32 v50, s54, v50
    v_mul_f32 v51, s54, v51
    v_mul_f32 v52, s54, v52
    v_mul_f32 v53, s54, v53
    v_mul_f32 v54, s54, v54
    v_mul_f32 v55, s54, v55
    s_cbranch_vccnz L_np_41
    s_waitcnt vmcnt(4)
L_np_41:
    s_waitcnt vmcnt(5)
    buffer_load_dwordx4 v[204:207], v12, s[8:11], s24 offen offset:256 nt
    s_add_u32 s56, s56, 98304
    s_sub_u32 s7, s56, 1572864
    s_cselect_b32 s56, s56, s7
    s_add_u32 s39, s39, 1
    v_mov_b32 v8, s39
    ds_write_b32 v14, v8 offset:24
    v_cvt_pk_bf16_f32 v4, v48, v49
    v_cvt_pk_bf16_f32 v5, v50, v51
    v_cvt_pk_bf16_f32 v6, v52, v53
    v_cvt_pk_bf16_f32 v7, v54, v55
    v_lshlrev_b32 v48, 16, v4
    v_and_b32 v49, s53, v4
    v_lshlrev_b32 v50, 16, v5
    s_add_u32 s24, s56, s57
    s_add_u32 s38, s38, s37
    s_cselect_b64 vcc, -1, 0
    s_cbranch_vccnz L_np_42
    s_waitcnt vmcnt(4)
L_np_42:
    s_waitcnt vmcnt(5)
    buffer_load_dwordx4 v[208:211], v12, s[8:11], s24 offen offset:0 nt
    v_and_b32 v51, s53, v5
    v_lshlrev_b32 v52, 16, v6
    v_and_b32 v53, s53, v6
    v_lshlrev_b32 v54, 16, v7
    v_and_b32 v55, s53, v7
    v_max3_f32 v4, v40, v41, v42
    v_max3_f32 v5, v43, v44, v45
    v_max3_f32 v6, v46, v47, v48
    s_cbranch_vccnz L_np_43
    s_waitcnt vmcnt(4)
L_np_43:
    s_waitcnt vmcnt(5)
    buffer_load_dwordx4 v[212:215], v12, s[8:11], s24 offen offset:128 nt
    v_max3_f32 v7, v49, v50, v51
    v_max3_f32 v4, v4, v52, v53
    v_max3_f32 v5, v5, v54, v55
    v_max3_f32 v4, v4, v6, v7
    v_max_f32 v4, v4, v5
    s_nop 1
    v_max_f32_dpp v4, v4, v4 row_ror:8 row_mask:0xf bank_mask:0xf
    v_mov_b32 v5, v4
    s_nop 1
    v_permlane16_swap_b32 v4, v5
    s_cbranch_vccnz L_np_44
    s_waitcnt vmcnt(4)
L_np_44:
    s_waitcnt vmcnt(5)
    buffer_load_dwordx4 v[216:219], v12, s[8:11], s24 offen offset:256 nt
    s_add_u32 s56, s56, 98304
    s_sub_u32 s7, s56, 1572864
    s_cselect_b32 s56, s56, s7
    v_max_f32 v4, v4, v5
    v_mov_b32 v5, v4
    s_nop 1
    v_permlane32_swap_b32 v4, v5
    v_max_f32 v4, v4, v5
    v_mul_f32 v9, s55, v4
    v_fma_f32 v40, v40, s55, -v9
    v_fma_f32 v41, v41, s55, -v9
    s_add_u32 s24, s56, s57
    s_add_u32 s38, s38, s37
    s_cselect_b64 vcc, -1, 0
    s_cbranch_vccnz L_np_45
    s_waitcnt vmcnt(4)
L_np_45:
    s_waitcnt vmcnt(5)
    buffer_load_dwordx4 v[220:223], v12, s[8:11], s24 offen offset:0 nt
    v_fma_f32 v42, v42, s55, -v9
    v_fma_f32 v43, v43, s55, -v9
    v_fma_f32 v44, v44, s55, -v9
    v_fma_f32 v45, v45, s55, -v9
    v_fma_f32 v46, v46, s55, -v9
    v_fma_f32 v47, v47, s55, -v9
    v_fma_f32 v48, v48, s55, -v9
    v_fma_f32 v49, v49, s55, -v9
    s_cbranch_vccnz L_np_46
    s_waitcnt vmcnt(4)
L_np_46:
    s_waitcnt vmcnt(5)
    buffer_load_dwordx4 v[224:227], v12, s[8:11], s24 offen offset:128 nt
    v_fma_f32 v50, v50, s55, -v9
    v_fma_f32 v51, v51, s55, -v9
    v_fma_f32 v52, v52, s55, -v9
    v_fma_f32 v53, v53, s55, -v9
    v_fma_f32 v54, v54, s55, -v9
    v_fma_f32 v55, v55, s55, -v9
    v_exp_f32 v40, v40
    v_exp_f32 v41, v41
    s_cbranch_vccnz L_np_47
    s_waitcnt vmcnt(4)
L_np_47:
    s_waitcnt vmcnt(5)
    buffer_load_dwordx4 v[228:231], v12, s[8:11], s24 offen offset:256 nt
    s_add_u32 s56, s56, 98304
    s_sub_u32 s7, s56, 1572864
    s_cselect_b32 s56, s56, s7
    s_add_u32 s39, s39, 1
    v_mov_b32 v8, s39
    ds_write_b32 v14, v8 offset:24
    v_exp_f32 v42, v42
    v_exp_f32 v43, v43
    v_exp_f32 v44, v44
    v_exp_f32 v45, v45
    v_exp_f32 v46, v46
    v_exp_f32 v47, v47
    v_exp_f32 v48, v48
    s_add_u32 s24, s56, s57
    s_add_u32 s38, s38, s37
    s_cselect_b64 vcc, -1, 0
    s_cbranch_vccnz L_np_48
    s_waitcnt vmcnt(4)
L_np_48:
    s_waitcnt vmcnt(5)
    buffer_load_dwordx4 v[232:235], v12, s[8:11], s24 offen offset:0 nt
    v_exp_f32 v49, v49
    v_exp_f32 v50, v50
    v_exp_f32 v51, v51
    v_exp_f32 v52, v52
    v_exp_f32 v53, v53
    v_exp_f32 v54, v54
    v_exp_f32 v55, v55
    v_cvt_pk_bf16_f32 v28, v40, v41
    s_cbranch_vccnz L_np_49
    s_waitcnt vmcnt(4)
L_np_49:
    s_waitcnt vmcnt(5)
    buffer_load_dwordx4 v[236:239], v12, s[8:11], s24 offen offset:128 nt
    v_cvt_pk_bf16_f32 v29, v42, v43
    v_cvt_pk_bf16_f32 v30, v44, v45
    v_cvt_pk_bf16_f32 v31, v46, v47
    v_cvt_pk_bf16_f32 v32, v48, v49
    v_cvt_pk_bf16_f32 v33, v50, v51
    v_cvt_pk_bf16_f32 v34, v52, v53
    v_cvt_pk_bf16_f32 v35, v54, v55
    ds_write_b128 v3, v[28:31]
    s_cbranch_vccnz L_np_50
    s_waitcnt vmcnt(4)
L_np_50:
    s_waitcnt vmcnt(5)
    buffer_load_dwordx4 v[240:243], v12, s[8:11], s24 offen offset:256 nt
    s_add_u32 s56, s56, 98304
    s_sub_u32 s7, s56, 1572864
    s_cselect_b32 s56, s56, s7
    ds_write_b128 v3, v[32:35] offset:16
    s_nop 1
    v_add_u32 v3, 256, v3
    v_add_f32 v40, v40, v41
    v_add_f32 v42, v42, v43
    v_add_f32 v44, v44, v45
    v_add_f32 v46, v46, v47
    v_add_f32 v48, v48, v49
    s_add_u32 s24, s56, s57
    s_add_u32 s38, s38, s37
    s_cselect_b64 vcc, -1, 0
    s_cbranch_vccnz L_np_51
    s_waitcnt vmcnt(4)
L_np_51:
    s_waitcnt vmcnt(5)
    buffer_load_dwordx4 v[244:247], v12, s[8:11], s24 offen offset:0 nt
    v_add_f32 v50, v50, v51
    v_add_f32 v52, v52, v53
    v_add_f32 v54, v54, v55
    v_add_f32 v40, v40, v42
    v_add_f32 v44, v44, v46
    v_add_f32 v48, v48, v50
    v_add_f32 v52, v52, v54
    v_add_f32 v40, v40, v44
    s_cbranch_vccnz L_np_52
    s_waitcnt vmcnt(4)
L_np_52:
    s_waitcnt vmcnt(5)
    buffer_load_dwordx4 v[248:251], v12, s[8:11], s24 offen offset:128 nt
    v_add_f32 v48, v48, v52
    v_add_f32 v10, v40, v48
    s_nop 1
    v_add_f32_dpp v10, v10, v10 row_ror:8 row_mask:0xf bank_mask:0xf
    s_lshl_b32 s34, s3, 3
    s_add_u32 s34, s34, s32
    v_mov_b32 v5, v10
    v_mov_b32 v7, s34
    v_mov_b32 v4, v9
    s_cbranch_vccnz L_np_53
    s_waitcnt vmcnt(4)
L_np_53:
    s_waitcnt vmcnt(5)
    buffer_load_dwordx4 v[252:255], v12, s[8:11], s24 offen offset:256 nt
    s_add_u32 s56, s56, 98304
    s_sub_u32 s7, s56, 1572864
    s_cselect_b32 s56, s56, s7
    s_add_u32 s39, s39, 1
    v_mov_b32 v8, s39
    ds_write_b32 v14, v8 offset:24
    v_permlane16_swap_b32 v10, v5
    v_add_f32 v10, v10, v5
    v_mov_b32 v5, v10
    v_mov_b32 v15, s33
    s_nop 0
    v_permlane32_swap_b32 v10, v5
    v_add_f32 v5, v10, v5
    s_mov_b64 exec, 1
    ds_write_b64 v7, v[4:5]
    s_mov_b64 exec, -1
    s_add_u32 s32, s32, 32
    s_add_u32 s25, s25, 1
    s_cmp_lt_u32 s25, 4
    s_cbranch_scc1 L_sloop
    v_subrev_u32 v3, 1024, v3
    ds_read_b128 v[16:19], v3
    ds_read_b128 v[20:23], v3 offset:16
    v_add_u32 v3, 256, v3
L_vloop:
    s_add_u32 s57, s57, 50331648
    s_waitcnt lgkmcnt(0)
    v_perm_b32 v6, v16, v16, s35
    v_and_b32 v60, v6, v56
    v_and_b32 v61, v6, v57
    v_and_b32 v62, v6, v58
    v_and_b32 v63, v6, v59
    s_nop 1
    v_mfma_f32_16x16x32_bf16 v[28:31], v[60:63], v[64:67], 0
    v_mfma_f32_16x16x32_bf16 v[32:35], v[60:63], v[68:71], 0
    v_mfma_f32_16x16x32_bf16 v[36:39], v[60:63], v[72:75], 0
    s_add_u32 s24, s56, s57
    s_add_u32 s38, s38, s37
    s_cselect_b64 vcc, -1, 0
    s_cbranch_vccnz L_np_54
    s_waitcnt vmcnt(4)
L_np_54:
    s_waitcnt vmcnt(5)
    buffer_load_dwordx4 v[64:67], v12, s[8:11], s24 offen offset:0 nt
    v_perm_b32 v6, v16, v16, s36
    v_and_b32 v60, v6, v56
    s_cbranch_vccnz L_np_55
    s_waitcnt vmcnt(4)
L_np_55:
    s_waitcnt vmcnt(5)
    buffer_load_dwordx4 v[68:71], v12, s[8:11], s24 offen offset:128 nt
    v_and_b32 v61, v6, v57
    v_and_b32 v62, v6, v58
    s_cbranch_vccnz L_np_56
    s_waitcnt vmcnt(4)
L_np_56:
    s_waitcnt vmcnt(5)
    buffer_load_dwordx4 v[72:75], v12, s[8:11], s24 offen offset:256 nt
    s_add_u32 s56, s56, 98304
    s_sub_u32 s7, s56, 1572864
    s_cselect_b32 s56, s56, s7
    v_and_b32 v63, v6, v59
    s_nop 1
    v_mfma_f32_16x16x32_bf16 v[28:31], v[60:63], v[76:79], v[28:31]
    v_mfma_f32_16x16x32_bf16 v[32:35], v[60:63], v[80:83], v[32:35]
    v_mfma_f32_16x16x32_bf16 v[36:39], v[60:63], v[84:87], v[36:39]
    s_add_u32 s24, s56, s57
    s_add_u32 s38, s38, s37
    s_cselect_b64 vcc, -1, 0
    s_cbranch_vccnz L_np_57
    s_waitcnt vmcnt(4)
L_np_57:
    s_waitcnt vmcnt(5)
    buffer_load_dwordx4 v[76:79], v12, s[8:11], s24 offen offset:0 nt
    v_perm_b32 v6, v17, v17, s35
    v_and_b32 v60, v6, v56
    s_cbranch_vccnz L_np_58
    s_waitcnt vmcnt(4)
L_np_58:
    s_waitcnt vmcnt(5)
    buffer_load_dwordx4 v[80:83], v12, s[8:11], s24 offen offset:128 nt
    v_and_b32 v61, v6, v57
    v_and_b32 v62, v6, v58
    s_cbranch_vccnz L_np_59
    s_waitcnt vmcnt(4)
L_np_59:
    s_waitcnt vmcnt(5)
    buffer_load_dwordx4 v[84:87], v12, s[8:11], s24 offen offset:256 nt
    s_add_u32 s56, s56, 98304
    s_sub_u32 s7, s56, 1572864
    s_cselect_b32 s56, s56, s7
    v_and_b32 v63, v6, v59
    s_add_u32 s39, s39, 1
    v_mov_b32 v8, s39
    ds_write_b32 v14, v8 offset:24
    v_mfma_f32_16x16x32_bf16 v[28:31], v[60:63], v[88:91], v[28:31]
    v_mfma_f32_16x16x32_bf16 v[32:35], v[60:63], v[92:95], v[32:35]
    v_mfma_f32_16x16x32_bf16 v[36:39], v[60:63], v[96:99], v[36:39]
    s_add_u32 s24, s56, s57
    s_add_u32 s38, s38, s37
    s_cselect_b64 vcc, -1, 0
    s_cbranch_vccnz L_np_60
    s_waitcnt vmcnt(4)
L_np_60:
    s_waitcnt vmcnt(5)
    buffer_load_dwordx4 v[88:91], v12, s[8:11], s24 offen offset:0 nt
    v_perm_b32 v6, v17, v17, s36
    v_and_b32 v60, v6, v56
    s_cbranch_vccnz L_np_61
    s_waitcnt vmcnt(4)
L_np_61:
    s_waitcnt vmcnt(5)
    buffer_load_dwordx4 v[92:95], v12, s[8:11], s24 offen offset:128 nt
    v_and_b32 v61, v6, v57
    v_and_b32 v62, v6, v58
    s_cbranch_vccnz L_np_62
    s_waitcnt vmcnt(4)
L_np_62:
    s_waitcnt vmcnt(5)
    buffer_load_dwordx4 v[96:99], v12, s[8:11], s24 offen offset:256 nt
    s_add_u32 s56, s56, 98304
    s_sub_u32 s7, s56, 1572864
    s_cselect_b32 s56, s56, s7
    v_and_b32 v63, v6, v59
    s_nop 1
    v_mfma_f32_16x16x32_bf16 v[28:31], v[60:63], v[100:103], v[28:31]
    v_mfma_f32_16x16x32_bf16 v[32:35], v[60:63], v[104:107], v[32:35]
    v_mfma_f32_16x16x32_bf16 v[36:39], v[60:63], v[108:111], v[36:39]
    s_add_u32 s24, s56, s57
    s_add_u32 s38, s38, s37
    s_cselect_b64 vcc, -1, 0
    s_cbranch_vccnz L_np_63
    s_waitcnt vmcnt(4)
L_np_63:
    s_waitcnt vmcnt(5)
    buffer_load_dwordx4 v[100:103], v12, s[8:11], s24 offen offset:0 nt
    v_perm_b32 v6, v18, v18, s35
    v_and_b32 v60, v6, v56
    s_cbranch_vccnz L_np_64
    s_waitcnt vmcnt(4)
L_np_64:
    s_waitcnt vmcnt(5)
    buffer_load_dwordx4 v[104:107], v12, s[8:11], s24 offen offset:128 nt
    v_and_b32 v61, v6, v57
    v_and_b32 v62, v6, v58
    s_cbranch_vccnz L_np_65
    s_waitcnt vmcnt(4)
L_np_65:
    s_waitcnt vmcnt(5)
    buffer_load_dwordx4 v[108:111], v12, s[8:11], s24 offen offset:256 nt
    s_add_u32 s56, s56, 98304
    s_sub_u32 s7, s56, 1572864
    s_cselect_b32 s56, s56, s7
    v_and_b32 v63, v6, v59
    s_add_u32 s39, s39, 1
    v_mov_b32 v8, s39
    ds_write_b32 v14, v8 offset:24
    v_mfma_f32_16x16x32_bf16 v[28:31], v[60:63], v[112:115], v[28:31]
    v_mfma_f32_16x16x32_bf16 v[32:35], v[60:63], v[116:119], v[32:35]
    v_mfma_f32_16x16x32_bf16 v[36:39], v[60:63], v[120:123], v[36:39]
    s_add_u32 s24, s56, s57
    s_add_u32 s38, s38, s37
    s_cselect_b64 vcc, -1, 0
    s_cbranch_vccnz L_np_66
    s_waitcnt vmcnt(4)
L_np_66:
    s_waitcnt vmcnt(5)
    buffer_load_dwordx4 v[112:115], v12, s[8:11], s24 offen offset:0 nt
    v_perm_b32 v6, v18, v18, s36
    v_and_b32 v60, v6, v56
    s_cbranch_vccnz L_np_67
    s_waitcnt vmcnt(4)
L_np_67:
    s_waitcnt vmcnt(5)
    buffer_load_dwordx4 v[116:119], v12, s[8:11], s24 offen offset:128 nt
    v_and_b32 v61, v6, v57
    v_and_b32 v62, v6, v58
    s_cbranch_vccnz L_np_68
    s_waitcnt vmcnt(4)
L_np_68:
    s_waitcnt vmcnt(5)
    buffer_load_dwordx4 v[120:123], v12, s[8:11], s24 offen offset:256 nt
    s_add_u32 s56, s56, 98304
    s_sub_u32 s7, s56, 1572864
    s_cselect_b32 s56, s56, s7
    v_and_b32 v63, v6, v59
    s_nop 1
    v_mfma_f32_16x16x32_bf16 v[28:31], v[60:63], v[124:127], v[28:31]
    v_mfma_f32_16x16x32_bf16 v[32:35], v[60:63], v[128:131], v[32:35]
    v_mfma_f32_16x16x32_bf16 v[36:39], v[60:63], v[132:135], v[36:39]
    s_add_u32 s24, s56, s57
    s_add_u32 s38, s38, s37
    s_cselect_b64 vcc, -1, 0
    s_cbranch_vccnz L_np_69
    s_waitcnt vmcnt(4)
L_np_69:
    s_waitcnt vmcnt(5)
    buffer_load_dwordx4 v[124:127], v12, s[8:11], s24 offen offset:0 nt
    v_perm_b32 v6, v19, v19, s35
    v_and_b32 v60, v6, v56
    s_cbranch_vccnz L_np_70
    s_waitcnt vmcnt(4)
L_np_70:
    s_waitcnt vmcnt(5)
    buffer_load_dwordx4 v[128:131], v12, s[8:11], s24 offen offset:128 nt
    v_and_b32 v61, v6, v57
    v_and_b32 v62, v6, v58
    s_cbranch_vccnz L_np_71
    s_waitcnt vmcnt(4)
L_np_71:
    s_waitcnt vmcnt(5)
    buffer_load_dwordx4 v[132:135], v12, s[8:11], s24 offen offset:256 nt
    s_add_u32 s56, s56, 98304
    s_sub_u32 s7, s56, 1572864
    s_cselect_b32 s56, s56, s7
    v_and_b32 v63, v6, v59
    s_add_u32 s39, s39, 1
    v_mov_b32 v8, s39
    ds_write_b32 v14, v8 offset:24
    v_mfma_f32_16x16x32_bf16 v[28:31], v[60:63], v[136:139], v[28:31]
    v_mfma_f32_16x16x32_bf16 v[32:35], v[60:63], v[140:143], v[32:35]
    v_mfma_f32_16x16x32_bf16 v[36:39], v[60:63], v[144:147], v[36:39]
    s_add_u32 s24, s56, s57
    s_add_u32 s38, s38, s37
    s_cselect_b64 vcc, -1, 0
    s_cbranch_vccnz L_np_72
    s_waitcnt vmcnt(4)
L_np_72:
    s_waitcnt vmcnt(5)
    buffer_load_dwordx4 v[136:139], v12, s[8:11], s24 offen offset:0 nt
    v_perm_b32 v6, v19, v19, s36
    v_and_b32 v60, v6, v56
    s_cbranch_vccnz L_np_73
    s_waitcnt vmcnt(4)
L_np_73:
    s_waitcnt vmcnt(5)
    buffer_load_dwordx4 v[140:143], v12, s[8:11], s24 offen offset:128 nt
    v_and_b32 v61, v6, v57
    v_and_b32 v62, v6, v58
    s_cbranch_vccnz L_np_74
    s_waitcnt vmcnt(4)
L_np_74:
    s_waitcnt vmcnt(5)
    buffer_load_dwordx4 v[144:147], v12, s[8:11], s24 offen offset:256 nt
    s_add_u32 s56, s56, 98304
    s_sub_u32 s7, s56, 1572864
    s_cselect_b32 s56, s56, s7
    v_and_b32 v63, v6, v59
    s_nop 1
    v_mfma_f32_16x16x32_bf16 v[28:31], v[60:63], v[148:151], v[28:31]
    v_mfma_f32_16x16x32_bf16 v[32:35], v[60:63], v[152:155], v[32:35]
    v_mfma_f32_16x16x32_bf16 v[36:39], v[60:63], v[156:159], v[36:39]
    s_add_u32 s24, s56, s57
    s_add_u32 s38, s38, s37
    s_cselect_b64 vcc, -1, 0
    s_cbranch_vccnz L_np_75
    s_waitcnt vmcnt(4)
L_np_75:
    s_waitcnt vmcnt(5)
    buffer_load_dwordx4 v[148:151], v12, s[8:11], s24 offen offset:0 nt
    v_perm_b32 v6, v20, v20, s35
    v_and_b32 v60, v6, v56
    s_cbranch_vccnz L_np_76
    s_waitcnt vmcnt(4)
L_np_76:
    s_waitcnt vmcnt(5)
    buffer_load_dwordx4 v[152:155], v12, s[8:11], s24 offen offset:128 nt
    v_and_b32 v61, v6, v57
    v_and_b32 v62, v6, v58
    s_cbranch_vccnz L_np_77
    s_waitcnt vmcnt(4)
L_np_77:
    s_waitcnt vmcnt(5)
    buffer_load_dwordx4 v[156:159], v12, s[8:11], s24 offen offset:256 nt
    s_add_u32 s56, s56, 98304
    s_sub_u32 s7, s56, 1572864
    s_cselect_b32 s56, s56, s7
    v_and_b32 v63, v6, v59
    s_add_u32 s39, s39, 1
    v_mov_b32 v8, s39
    ds_write_b32 v14, v8 offset:24
    v_mfma_f32_16x16x32_bf16 v[28:31], v[60:63], v[160:163], v[28:31]
    v_mfma_f32_16x16x32_bf16 v[32:35], v[60:63], v[164:167], v[32:35]
    v_mfma_f32_16x16x32_bf16 v[36:39], v[60:63], v[168:171], v[36:39]
    s_add_u32 s24, s56, s57
    s_add_u32 s38, s38, s37
    s_cselect_b64 vcc, -1, 0
    s_cbranch_vccnz L_np_78
    s_waitcnt vmcnt(4)
L_np_78:
    s_waitcnt vmcnt(5)
    buffer_load_dwordx4 v[160:163], v12, s[8:11], s24 offen offset:0 nt
    v_perm_b32 v6, v20, v20, s36
    v_and_b32 v60, v6, v56
    s_cbranch_vccnz L_np_79
    s_waitcnt vmcnt(4)
L_np_79:
    s_waitcnt vmcnt(5)
    buffer_load_dwordx4 v[164:167], v12, s[8:11], s24 offen offset:128 nt
    v_and_b32 v61, v6, v57
    v_and_b32 v62, v6, v58
    s_cbranch_vccnz L_np_80
    s_waitcnt vmcnt(4)
L_np_80:
    s_waitcnt vmcnt(5)
    buffer_load_dwordx4 v[168:171], v12, s[8:11], s24 offen offset:256 nt
    s_add_u32 s56, s56, 98304
    s_sub_u32 s7, s56, 1572864
    s_cselect_b32 s56, s56, s7
    v_and_b32 v63, v6, v59
    s_nop 1
    v_mfma_f32_16x16x32_bf16 v[28:31], v[60:63], v[172:175], v[28:31]
    v_mfma_f32_16x16x32_bf16 v[32:35], v[60:63], v[176:179], v[32:35]
    v_mfma_f32_16x16x32_bf16 v[36:39], v[60:63], v[180:183], v[36:39]
    s_add_u32 s24, s56, s57
    s_add_u32 s38, s38, s37
    s_cselect_b64 vcc, -1, 0
    s_cbranch_vccnz L_np_81
    s_waitcnt vmcnt(4)
L_np_81:
    s_waitcnt vmcnt(5)
    buffer_load_dwordx4 v[172:175], v12, s[8:11], s24 offen offset:0 nt
    v_perm_b32 v6, v21, v21, s35
    v_and_b32 v60, v6, v56
    s_cbranch_vccnz L_np_82
    s_waitcnt vmcnt(4)
L_np_82:
    s_waitcnt vmcnt(5)
    buffer_load_dwordx4 v[176:179], v12, s[8:11], s24 offen offset:128 nt
    v_and_b32 v61, v6, v57
    v_and_b32 v62, v6, v58
    s_cbranch_vccnz L_np_83
    s_waitcnt vmcnt(4)
L_np_83:
    s_waitcnt vmcnt(5)
    buffer_load_dwordx4 v[180:183], v12, s[8:11], s24 offen offset:256 nt
    s_add_u32 s56, s56, 98304
    s_sub_u32 s7, s56, 1572864
    s_cselect_b32 s56, s56, s7
    v_and_b32 v63, v6, v59
    s_add_u32 s39, s39, 1
    v_mov_b32 v8, s39
    ds_write_b32 v14, v8 offset:24
    v_mfma_f32_16x16x32_bf16 v[28:31], v[60:63], v[184:187], v[28:31]
    v_mfma_f32_16x16x32_bf16 v[32:35], v[60:63], v[188:191], v[32:35]
    v_mfma_f32_16x16x32_bf16 v[36:39], v[60:63], v[192:195], v[36:39]
    s_add_u32 s24, s56, s57
    s_add_u32 s38, s38, s37
    s_cselect_b64 vcc, -1, 0
    s_cbranch_vccnz L_np_84
    s_waitcnt vmcnt(4)
L_np_84:
    s_waitcnt vmcnt(5)
    buffer_load_dwordx4 v[184:187], v12, s[8:11], s24 offen offset:0 nt
    v_perm_b32 v6, v21, v21, s36
    v_and_b32 v60, v6, v56
    s_cbranch_vccnz L_np_85
    s_waitcnt vmcnt(4)
L_np_85:
    s_waitcnt vmcnt(5)
    buffer_load_dwordx4 v[188:191], v12, s[8:11], s24 offen offset:128 nt
    v_and_b32 v61, v6, v57
    v_and_b32 v62, v6, v58
    s_cbranch_vccnz L_np_86
    s_waitcnt vmcnt(4)
L_np_86:
    s_waitcnt vmcnt(5)
    buffer_load_dwordx4 v[192:195], v12, s[8:11], s24 offen offset:256 nt
    s_add_u32 s56, s56, 98304
    s_sub_u32 s7, s56, 1572864
    s_cselect_b32 s56, s56, s7
    v_and_b32 v63, v6, v59
    s_nop 1
    v_mfma_f32_16x16x32_bf16 v[28:31], v[60:63], v[196:199], v[28:31]
    v_mfma_f32_16x16x32_bf16 v[32:35], v[60:63], v[200:203], v[32:35]
    v_mfma_f32_16x16x32_bf16 v[36:39], v[60:63], v[204:207], v[36:39]
    s_add_u32 s24, s56, s57
    s_add_u32 s38, s38, s37
    s_cselect_b64 vcc, -1, 0
    s_cbranch_vccnz L_np_87
    s_waitcnt vmcnt(4)
L_np_87:
    s_waitcnt vmcnt(5)
    buffer_load_dwordx4 v[196:199], v12, s[8:11], s24 offen offset:0 nt
    v_perm_b32 v6, v22, v22, s35
    v_and_b32 v60, v6, v56
    s_cbranch_vccnz L_np_88
    s_waitcnt vmcnt(4)
L_np_88:
    s_waitcnt vmcnt(5)
    buffer_load_dwordx4 v[200:203], v12, s[8:11], s24 offen offset:128 nt
    v_and_b32 v61, v6, v57
    v_and_b32 v62, v6, v58
    s_cbranch_vccnz L_np_89
    s_waitcnt vmcnt(4)
L_np_89:
    s_waitcnt vmcnt(5)
    buffer_load_dwordx4 v[204:207], v12, s[8:11], s24 offen offset:256 nt
    s_add_u32 s56, s56, 98304
    s_sub_u32 s7, s56, 1572864
    s_cselect_b32 s56, s56, s7
    v_and_b32 v63, v6, v59
    s_add_u32 s39, s39, 1
    v_mov_b32 v8, s39
    ds_write_b32 v14, v8 offset:24
    v_mfma_f32_16x16x32_bf16 v[28:31], v[60:63], v[208:211], v[28:31]
    v_mfma_f32_16x16x32_bf16 v[32:35], v[60:63], v[212:215], v[32:35]
    v_mfma_f32_16x16x32_bf16 v[36:39], v[60:63], v[216:219], v[36:39]
    s_add_u32 s24, s56, s57
    s_add_u32 s38, s38, s37
    s_cselect_b64 vcc, -1, 0
    s_cbranch_vccnz L_np_90
    s_waitcnt vmcnt(4)
L_np_90:
    s_waitcnt vmcnt(5)
    buffer_load_dwordx4 v[208:211], v12, s[8:11], s24 offen offset:0 nt
    v_perm_b32 v6, v22, v22, s36
    v_and_b32 v60, v6, v56
    s_cbranch_vccnz L_np_91
    s_waitcnt vmcnt(4)
L_np_91:
    s_waitcnt vmcnt(5)
    buffer_load_dwordx4 v[212:215], v12, s[8:11], s24 offen offset:128 nt
    v_and_b32 v61, v6, v57
    v_and_b32 v62, v6, v58
    s_cbranch_vccnz L_np_92
    s_waitcnt vmcnt(4)
L_np_92:
    s_waitcnt vmcnt(5)
    buffer_load_dwordx4 v[216:219], v12, s[8:11], s24 offen offset:256 nt
    s_add_u32 s56, s56, 98304
    s_sub_u32 s7, s56, 1572864
    s_cselect_b32 s56, s56, s7
    v_and_b32 v63, v6, v59
    s_nop 1
    v_mfma_f32_16x16x32_bf16 v[28:31], v[60:63], v[220:223], v[28:31]
    v_mfma_f32_16x16x32_bf16 v[32:35], v[60:63], v[224:227], v[32:35]
    v_mfma_f32_16x16x32_bf16 v[36:39], v[60:63], v[228:231], v[36:39]
    s_add_u32 s24, s56, s57
    s_add_u32 s38, s38, s37
    s_cselect_b64 vcc, -1, 0
    s_cbranch_vccnz L_np_93
    s_waitcnt vmcnt(4)
L_np_93:
    s_waitcnt vmcnt(5)
    buffer_load_dwordx4 v[220:223], v12, s[8:11], s24 offen offset:0 nt
    v_perm_b32 v6, v23, v23, s35
    v_and_b32 v60, v6, v56
    s_cbranch_vccnz L_np_94
    s_waitcnt vmcnt(4)
L_np_94:
    s_waitcnt vmcnt(5)
    buffer_load_dwordx4 v[224:227], v12, s[8:11], s24 offen offset:128 nt
    v_and_b32 v61, v6, v57
    v_and_b32 v62, v6, v58
    s_cbranch_vccnz L_np_95
    s_waitcnt vmcnt(4)
L_np_95:
    s_waitcnt vmcnt(5)
    buffer_load_dwordx4 v[228:231], v12, s[8:11], s24 offen offset:256 nt
    s_add_u32 s56, s56, 98304
    s_sub_u32 s7, s56, 1572864
    s_cselect_b32 s56, s56, s7
    v_and_b32 v63, v6, v59
    s_add_u32 s39, s39, 1
    v_mov_b32 v8, s39
    ds_write_b32 v14, v8 offset:24
    v_mfma_f32_16x16x32_bf16 v[28:31], v[60:63], v[232:235], v[28:31]
    v_mfma_f32_16x16x32_bf16 v[32:35], v[60:63], v[236:239], v[32:35]
    v_mfma_f32_16x16x32_bf16 v[36:39], v[60:63], v[240:243], v[36:39]
    s_add_u32 s24, s56, s57
    s_add_u32 s38, s38, s37
    s_cselect_b64 vcc, -1, 0
    s_cbranch_vccnz L_np_96
    s_waitcnt vmcnt(4)
L_np_96:
    s_waitcnt vmcnt(5)
    buffer_load_dwordx4 v[232:235], v12, s[8:11], s24 offen offset:0 nt
    v_perm_b32 v6, v23, v23, s36
    v_and_b32 v60, v6, v56
    s_cbranch_vccnz L_np_97
    s_waitcnt vmcnt(4)
L_np_97:
    s_waitcnt vmcnt(5)
    buffer_load_dwordx4 v[236:239], v12, s[8:11], s24 offen offset:128 nt
    v_and_b32 v61, v6, v57
    v_and_b32 v62, v6, v58
    s_cbranch_vccnz L_np_98
    s_waitcnt vmcnt(4)
L_np_98:
    s_waitcnt vmcnt(5)
    buffer_load_dwordx4 v[240:243], v12, s[8:11], s24 offen offset:256 nt
    s_add_u32 s56, s56, 98304
    s_sub_u32 s7, s56, 1572864
    s_cselect_b32 s56, s56, s7
    v_and_b32 v63, v6, v59
    ds_read_b128 v[16:19], v3
    ds_read_b128 v[20:23], v3 offset:16
    v_add_u32 v3, 256, v3
    v_mov_b32 v15, s33
    v_mov_b32 v7, 1
    v_mfma_f32_16x16x32_bf16 v[28:31], v[60:63], v[244:247], v[28:31]
    v_mfma_f32_16x16x32_bf16 v[32:35], v[60:63], v[248:251], v[32:35]
    v_mfma_f32_16x16x32_bf16 v[36:39], v[60:63], v[252:255], v[36:39]
    s_add_u32 s24, s56, s57
    s_add_u32 s38, s38, s37
    s_cselect_b64 vcc, -1, 0
    s_cbranch_vccnz L_np_99
    s_waitcnt vmcnt(4)
L_np_99:
    s_waitcnt vmcnt(5)
    buffer_load_dwordx4 v[244:247], v12, s[8:11], s24 offen offset:0 nt
    s_cbranch_vccnz L_np_100
    s_waitcnt vmcnt(4)
L_np_100:
    s_waitcnt vmcnt(5)
    buffer_load_dwordx4 v[248:251], v12, s[8:11], s24 offen offset:128 nt
    s_cbranch_vccnz L_np_101
    s_waitcnt vmcnt(4)
L_np_101:
    s_waitcnt vmcnt(5)
    buffer_load_dwordx4 v[252:255], v12, s[8:11], s24 offen offset:256 nt
    s_add_u32 s56, s56, 98304
    s_sub_u32 s7, s56, 1572864
    s_cselect_b32 s56, s56, s7
    s_mov_b32 exec_lo, 0x00ff00ff
    s_mov_b32 exec_hi, 0xff00ff00
    ds_write_b128 v13, v[28:31] offset:0
    ds_write_b128 v13, v[32:35] offset:256
    ds_write_b128 v13, v[36:39] offset:512
    s_mov_b64 exec, 1
    ds_add_u32 v15, v7
    s_mov_b64 exec, -1
    s_add_u32 s39, s39, 1
    v_mov_b32 v8, s39
    ds_write_b32 v14, v8 offset:24
    v_add_u32 v13, 6144, v13
    s_add_u32 s33, s33, 4
    s_add_u32 s25, s25, 1
    s_cmp_lt_u32 s25, 7
    s_cbranch_scc1 L_vloop
L_final:
    s_waitcnt lgkmcnt(0)
    v_perm_b32 v6, v16, v16, s35
    v_and_b32 v60, v6, v56
    v_and_b32 v61, v6, v57
    v_and_b32 v62, v6, v58
    v_and_b32 v63, v6, v59
    v_perm_b32 v6, v16, v16, s36
    v_and_b32 v40, v6, v56
    v_and_b32 v41, v6, v57
    v_and_b32 v42, v6, v58
    v_and_b32 v43, v6, v59
    v_mfma_f32_16x16x32_bf16 v[28:31], v[60:63], v[64:67], 0
    v_mfma_f32_16x16x32_bf16 v[32:35], v[60:63], v[68:71], 0
    v_mfma_f32_16x16x32_bf16 v[36:39], v[60:63], v[72:75], 0
    v_perm_b32 v6, v17, v17, s35
    v_and_b32 v60, v6, v56
    v_and_b32 v61, v6, v57
    v_and_b32 v62, v6, v58
    v_and_b32 v63, v6, v59
    v_mfma_f32_16x16x32_bf16 v[28:31], v[40:43], v[76:79], v[28:31]
    v_mfma_f32_16x16x32_bf16 v[32:35], v[40:43], v[80:83], v[32:35]
    v_mfma_f32_16x16x32_bf16 v[36:39], v[40:43], v[84:87], v[36:39]
    v_perm_b32 v6, v17, v17, s36
    v_and_b32 v40, v6, v56
    v_and_b32 v41, v6, v57
    v_and_b32 v42, v6, v58
    v_and_b32 v43, v6, v59
    v_mfma_f32_16x16x32_bf16 v[28:31], v[60:63], v[88:91], v[28:31]
    v_mfma_f32_16x16x32_bf16 v[32:35], v[60:63], v[92:95], v[32:35]
    v_mfma_f32_16x16x32_bf16 v[36:39], v[60:63], v[96:99], v[36:39]
    v_perm_b32 v6, v18, v18, s35
    v_and_b32 v60, v6, v56
    v_and_b32 v61, v6, v57
    v_and_b32 v62, v6, v58
    v_and_b32 v63, v6, v59
    v_mfma_f32_16x16x32_bf16 v[28:31], v[40:43], v[100:103], v[28:31]
    v_mfma_f32_16x16x32_bf16 v[32:35], v[40:43], v[104:107], v[32:35]
    v_mfma_f32_16x16x32_bf16 v[36:39], v[40:43], v[108:111], v[36:39]
    v_perm_b32 v6, v18, v18, s36
    v_and_b32 v40, v6, v56
    v_and_b32 v41, v6, v57
    v_and_b32 v42, v6, v58
    v_and_b32 v43, v6, v59
    v_mfma_f32_16x16x32_bf16 v[28:31], v[60:63], v[112:115], v[28:31]
    v_mfma_f32_16x16x32_bf16 v[32:35], v[60:63], v[116:119], v[32:35]
    v_mfma_f32_16x16x32_bf16 v[36:39], v[60:63], v[120:123], v[36:39]
    v_perm_b32 v6, v19, v19, s35
    v_and_b32 v60, v6, v56
    v_and_b32 v61, v6, v57
    v_and_b32 v62, v6, v58
    v_and_b32 v63, v6, v59
    v_mfma_f32_16x16x32_bf16 v[28:31], v[40:43], v[124:127], v[28:31]
    v_mfma_f32_16x16x32_bf16 v[32:35], v[40:43], v[128:131], v[32:35]
    v_mfma_f32_16x16x32_bf16 v[36:39], v[40:43], v[132:135], v[36:39]
    v_perm_b32 v6, v19, v19, s36
    v_and_b32 v40, v6, v56
    v_and_b32 v41, v6, v57
    v_and_b32 v42, v6, v58
    v_and_b32 v43, v6, v59
    v_mfma_f32_16x16x32_bf16 v[28:31], v[60:63], v[136:139], v[28:31]
    v_mfma_f32_16x16x32_bf16 v[32:35], v[60:63], v[140:143], v[32:35]
    v_mfma_f32_16x16x32_bf16 v[36:39], v[60:63], v[144:147], v[36:39]
    v_perm_b32 v6, v20, v20, s35
    v_and_b32 v60, v6, v56
    v_and_b32 v61, v6, v57
    v_and_b32 v62, v6, v58
    v_and_b32 v63, v6, v59
    v_mfma_f32_16x16x32_bf16 v[28:31], v[40:43], v[148:151], v[28:31]
    v_mfma_f32_16x16x32_bf16 v[32:35], v[40:43], v[152:155], v[32:35]
    v_mfma_f32_16x16x32_bf16 v[36:39], v[40:43], v[156:159], v[36:39]
    v_perm_b32 v6, v20, v20, s36
    v_and_b32 v40, v6, v56
    v_and_b32 v41, v6, v57
    v_and_b32 v42, v6, v58
    v_and_b32 v43, v6, v59
    v_mfma_f32_16x16x32_bf16 v[28:31], v[60:63], v[160:163], v[28:31]
    v_mfma_f32_16x16x32_bf16 v[32:35], v[60:63], v[164:167], v[32:35]
    v_mfma_f32_16x16x32_bf16 v[36:39], v[60:63], v[168:171], v[36:39]
    v_perm_b32 v6, v21, v21, s35
    v_and_b32 v60, v6, v56
    v_and_b32 v61, v6, v57
    v_and_b32 v62, v6, v58
    v_and_b32 v63, v6, v59
    v_mfma_f32_16x16x32_bf16 v[28:31], v[40:43], v[172:175], v[28:31]
    v_mfma_f32_16x16x32_bf16 v[32:35], v[40:43], v[176:179], v[32:35]
    v_mfma_f32_16x16x32_bf16 v[36:39], v[40:43], v[180:183], v[36:39]
    v_perm_b32 v6, v21, v21, s36
    v_and_b32 v40, v6, v56
    v_and_b32 v41, v6, v57
    v_and_b32 v42, v6, v58
    v_and_b32 v43, v6, v59
    v_mfma_f32_16x16x32_bf16 v[28:31], v[60:63], v[184:187], v[28:31]
    v_mfma_f32_16x16x32_bf16 v[32:35], v[60:63], v[188:191], v[32:35]
    v_mfma_f32_16x16x32_bf16 v[36:39], v[60:63], v[192:195], v[36:39]
    v_perm_b32 v6, v22, v22, s35
    v_and_b32 v60, v6, v56
    v_and_b32 v61, v6, v57
    v_and_b32 v62, v6, v58
    v_and_b32 v63, v6, v59
    v_mfma_f32_16x16x32_bf16 v[28:31], v[40:43], v[196:199], v[28:31]
    v_mfma_f32_16x16x32_bf16 v[32:35], v[40:43], v[200:203], v[32:35]
    v_mfma_f32_16x16x32_bf16 v[36:39], v[40:43], v[204:207], v[36:39]
    v_perm_b32 v6, v22, v22, s36
    v_and_b32 v40, v6, v56
    v_and_b32 v41, v6, v57
    v_and_b32 v42, v6, v58
    v_and_b32 v43, v6, v59
    v_mfma_f32_16x16x32_bf16 v[28:31], v[60:63], v[208:211], v[28:31]
    v_mfma_f32_16x16x32_bf16 v[32:35], v[60:63], v[212:215], v[32:35]
    v_mfma_f32_16x16x32_bf16 v[36:39], v[60:63], v[216:219], v[36:39]
    v_perm_b32 v6, v23, v23, s35
    v_and_b32 v60, v6, v56
    v_and_b32 v61, v6, v57
    v_and_b32 v62, v6, v58
    v_and_b32 v63, v6, v59
    s_waitcnt vmcnt(6)
    v_mfma_f32_16x16x32_bf16 v[28:31], v[40:43], v[220:223], v[28:31]
    v_mfma_f32_16x16x32_bf16 v[32:35], v[40:43], v[224:227], v[32:35]
    v_mfma_f32_16x16x32_bf16 v[36:39], v[40:43], v[228:231], v[36:39]
    v_perm_b32 v6, v23, v23, s36
    v_and_b32 v40, v6, v56
    v_and_b32 v41, v6, v57
    v_and_b32 v42, v6, v58
    v_and_b32 v43, v6, v59
    v_mov_b32 v15, s33
    v_mov_b32 v7, 1
    v_mov_b32 v8, 146272
    s_waitcnt vmcnt(3)
    v_mfma_f32_16x16x32_bf16 v[28:31], v[60:63], v[232:235], v[28:31]
    v_mfma_f32_16x16x32_bf16 v[32:35], v[60:63], v[236:239], v[32:35]
    v_mfma_f32_16x16x32_bf16 v[36:39], v[60:63], v[240:243], v[36:39]
    s_waitcnt vmcnt(0)
    v_mfma_f32_16x16x32_bf16 v[28:31], v[40:43], v[244:247], v[28:31]
    v_mfma_f32_16x16x32_bf16 v[32:35], v[40:43], v[248:251], v[32:35]
    v_mfma_f32_16x16x32_bf16 v[36:39], v[40:43], v[252:255], v[36:39]
    s_mov_b32 exec_lo, 0x00ff00ff
    s_mov_b32 exec_hi, 0xff00ff00
    s_nop 3
    ds_write_b128 v13, v[28:31] offset:0
    ds_write_b128 v13, v[32:35] offset:256
    ds_write_b128 v13, v[36:39] offset:512
    s_mov_b64 exec, 1
    ds_add_rtn_u32 v7, v15, v7
    s_mov_b64 exec, -1
    ds_read_b128 v[16:19], v8
    ds_read_b128 v[20:23], v8 offset:16
    ds_read_b64 v[24:25], v0 offset:0
    ds_read_b64 v[26:27], v0 offset:8
    ds_read_b64 v[28:29], v0 offset:16
    ds_read_b64 v[30:31], v0 offset:1536
    ds_read_b64 v[32:33], v0 offset:1544
    ds_read_b64 v[34:35], v0 offset:1552
    ds_read_b64 v[36:37], v0 offset:3072
    ds_read_b64 v[38:39], v0 offset:3080
    ds_read_b64 v[40:41], v0 offset:3088
    ds_read_b64 v[42:43], v0 offset:4608
    ds_read_b64 v[44:45], v0 offset:4616
    ds_read_b64 v[46:47], v0 offset:4624
    s_waitcnt lgkmcnt(14)
    v_readfirstlane_b32 s7, v7
    s_nop 0
    s_cmp_lg_u32 s7, 3
    s_cbranch_scc1 L_nl_102
    s_waitcnt lgkmcnt(12)
    v_max3_f32 v48, v16, v18, v20
    v_max_f32 v48, v48, v22
    v_sub_f32 v16, v16, v48
    v_sub_f32 v18, v18, v48
    v_sub_f32 v20, v20, v48
    v_sub_f32 v22, v22, v48
    v_exp_f32 v16, v16
    v_exp_f32 v18, v18
    v_exp_f32 v20, v20
    v_exp_f32 v22, v22
    v_mul_f32 v49, v16, v17
    v_fmac_f32 v49, v18, v19
    v_fmac_f32 v49, v20, v21
    v_fmac_f32 v49, v22, v23
    v_rcp_f32 v50, v49
    s_waitcnt lgkmcnt(0)
    v_pk_mul_f32 v[24:25], v[24:25], v[16:17] op_sel_hi:[1,0]
    v_pk_mul_f32 v[26:27], v[26:27], v[16:17] op_sel_hi:[1,0]
    v_pk_mul_f32 v[28:29], v[28:29], v[16:17] op_sel_hi:[1,0]
    v_pk_fma_f32 v[24:25], v[30:31], v[18:19], v[24:25] op_sel_hi:[1,0,1]
    v_pk_fma_f32 v[26:27], v[32:33], v[18:19], v[26:27] op_sel_hi:[1,0,1]
    v_pk_fma_f32 v[28:29], v[34:35], v[18:19], v[28:29] op_sel_hi:[1,0,1]
    v_pk_fma_f32 v[24:25], v[36:37], v[20:21], v[24:25] op_sel_hi:[1,0,1]
    v_pk_fma_f32 v[26:27], v[38:39], v[20:21], v[26:27] op_sel_hi:[1,0,1]
    v_pk_fma_f32 v[28:29], v[40:41], v[20:21], v[28:29] op_sel_hi:[1,0,1]
    v_pk_fma_f32 v[24:25], v[42:43], v[22:23], v[24:25] op_sel_hi:[1,0,1]
    v_pk_fma_f32 v[26:27], v[44:45], v[22:23], v[26:27] op_sel_hi:[1,0,1]
    v_pk_fma_f32 v[28:29], v[46:47], v[22:23], v[28:29] op_sel_hi:[1,0,1]
    v_permlane32_swap_b32 v24, v25
    v_permlane32_swap_b32 v26, v27
    v_permlane32_swap_b32 v28, v29
    v_add_f32 v24, v24, v25
    v_add_f32 v26, v26, v27
    v_add_f32 v28, v28, v29
    v_mul_f32 v24, v50, v24
    v_mul_f32 v26, v50, v26
    v_mul_f32 v28, v50, v28
    v_mov_b32 v25, v24
    v_mov_b32 v27, v26
    v_mov_b32 v29, v28
    v_permlane32_swap_b32 v24, v25
    v_permlane32_swap_b32 v26, v27
    v_permlane32_swap_b32 v28, v29
    v_cvt_pk_bf16_f32 v52, v24, v25
    v_cvt_pk_bf16_f32 v53, v26, v27
    v_cvt_pk_bf16_f32 v54, v28, v29
    v_mov_b32 v55, s31
    s_mov_b32 exec_lo, 0
    s_mov_b32 exec_hi, 1
    v_mov_b32 v52, v48
    v_mov_b32 v53, v49
    s_mov_b32 exec_lo, -1
    s_cmp_eq_u32 s40, 0
    s_cbranch_scc1 L_s2_103
    buffer_store_dwordx4 v[52:55], v2, s[44:47], s30 offen
    s_branch L_s2e_104
L_s2_103:
    s_nop 7
    buffer_store_dwordx4 v[52:55], v2, s[44:47], s30 offen sc1
L_s2e_104:
    s_mov_b64 exec, 1
    v_mov_b32 v7, 1
    ds_add_u32 v15, v7
    s_mov_b64 exec, -1
L_nl_102:
    s_endpgm
L_w4:
    s_setprio 2
    s_mul_i32 s7, s6, 983040
    s_mul_i32 s56, s5, 384
    s_add_u32 s7, s7, s56
    s_add_u32 s8, s22, s7
    s_addc_u32 s9, s23, 0
    s_mov_b32 s10, 971136
    s_mov_b32 s11, 0x20000
    v_add_u32 v4, 0, v1
    v_mul_u32_u24 v5, 2731, v4
    v_lshrrev_b32 v5, 16, v5
    v_mul_u32_u24 v6, 24, v5
    v_sub_u32 v4, v4, v6
    v_mul_u32_u24 v5, 12288, v5
    v_lshl_add_u32 v232, v4, 4, v5
    v_add_u32 v4, 64, v1
    v_mul_u32_u24 v5, 2731, v4
    v_lshrrev_b32 v5, 16, v5
    v_mul_u32_u24 v6, 24, v5
    v_sub_u32 v4, v4, v6
    v_mul_u32_u24 v5, 12288, v5
    v_lshl_add_u32 v233, v4, 4, v5
    v_add_u32 v4, 128, v1
    v_mul_u32_u24 v5, 2731, v4
    v_lshrrev_b32 v5, 16, v5
    v_mul_u32_u24 v6, 24, v5
    v_sub_u32 v4, v4, v6
    v_mul_u32_u24 v5, 12288, v5
    v_lshl_add_u32 v234, v4, 4, v5
    s_mov_b32 s12, s16
    s_mov_b32 s13, s17
    s_mov_b32 s14, 5120
    s_mov_b32 s15, 0x20000
    v_and_b32 v15, 3, v1
    v_mul_u32_u24 v9, 1280, v15
    v_lshrrev_b32 v10, 2, v1
    v_lshl_add_u32 v10, v10, 4, v9
    buffer_load_dwordx4 v[16:19], v10, s[12:15], 0 offen offset:0
    buffer_load_dwordx4 v[20:23], v10, s[12:15], 0 offen offset:256
    buffer_load_dwordx4 v[24:27], v10, s[12:15], 0 offen offset:512
    buffer_load_dwordx4 v[28:31], v10, s[12:15], 0 offen offset:768
    buffer_load_dwordx4 v[32:35], v10, s[12:15], 0 offen offset:1024
    v_and_b32 v11, 12, v2
    v_add_u32 v11, v11, v3
    v_lshl_add_u32 v10, v11, 3, v9
    v_lshl_add_u32 v9, v3, 3, v9
    s_mul_i32 s7, s6, 160
    buffer_load_dwordx2 v[228:229], v10, s[12:15], s7 offen
    buffer_load_dwordx2 v[230:231], v9, s[12:15], s7 offen offset:128
    s_sub_u32 s7, s6, 4
    s_lshl_b32 s7, s7, 5
    s_add_u32 s7, s7, s5
    s_cmp_ge_u32 s7, 80
    s_cbranch_scc1 L_w4go
L_lw_105:
    ds_read_b32 v13, v14 offset:16
    s_waitcnt lgkmcnt(0)
    v_readfirstlane_b32 s7, v13
    s_nop 0
    s_cmp_lg_u32 s7, 0
    s_cbranch_scc1 L_lwd_106
    s_sub_u32 s52, s52, 1
    s_cbranch_scc1 L_timeout
    s_branch L_lw_105
L_lwd_106:
L_w4go:
    s_mov_b32 m0, 0
    s_mov_b32 s57, 0
    buffer_load_dwordx4 v232, s[8:11], s57 offen nt lds
    s_mov_b32 m0, 1024
    s_nop 0
    buffer_load_dwordx4 v233, s[8:11], s57 offen nt lds
    s_mov_b32 m0, 2048
    s_nop 0
    buffer_load_dwordx4 v234, s[8:11], s57 offen nt lds
    s_mov_b32 m0, 3072
    s_mov_b32 s57, 98304
    buffer_load_dwordx4 v232, s[8:11], s57 offen nt lds
    s_mov_b32 m0, 4096
    s_nop 0
    buffer_load_dwordx4 v233, s[8:11], s57 offen nt lds
    s_mov_b32 m0, 5120
    s_nop 0
    buffer_load_dwordx4 v234, s[8:11], s57 offen nt lds
    s_mov_b32 m0, 6144
    s_mov_b32 s57, 196608
    buffer_load_dwordx4 v232, s[8:11], s57 offen nt lds
    s_mov_b32 m0, 7168
    s_nop 0
    buffer_load_dwordx4 v233, s[8:11], s57 offen nt lds
    s_mov_b32 m0, 8192
    s_nop 0
    buffer_load_dwordx4 v234, s[8:11], s57 offen nt lds
    s_mov_b32 m0, 9216
    s_mov_b32 s57, 294912
    buffer_load_dwordx4 v232, s[8:11], s57 offen nt lds
    s_mov_b32 m0, 10240
    s_nop 0
    buffer_load_dwordx4 v233, s[8:11], s57 offen nt lds
    s_mov_b32 m0, 11264
    s_nop 0
    buffer_load_dwordx4 v234, s[8:11], s57 offen nt lds
    s_mov_b32 m0, 12288
    s_mov_b32 s57, 393216
    buffer_load_dwordx4 v232, s[8:11], s57 offen nt lds
    s_mov_b32 m0, 13312
    s_nop 0
    buffer_load_dwordx4 v233, s[8:11], s57 offen nt lds
    s_mov_b32 m0, 14336
    s_nop 0
    buffer_load_dwordx4 v234, s[8:11], s57 offen nt lds
    s_mov_b32 m0, 15360
    s_mov_b32 s57, 491520
    buffer_load_dwordx4 v232, s[8:11], s57 offen nt lds
    s_mov_b32 m0, 16384
    s_nop 0
    buffer_load_dwordx4 v233, s[8:11], s57 offen nt lds
    s_mov_b32 m0, 17408
    s_nop 0
    buffer_load_dwordx4 v234, s[8:11], s57 offen nt lds
    s_mov_b32 m0, 18432
    s_mov_b32 s57, 589824
    buffer_load_dwordx4 v232, s[8:11], s57 offen nt lds
    s_mov_b32 m0, 19456
    s_nop 0
    buffer_load_dwordx4 v233, s[8:11], s57 offen nt lds
    s_mov_b32 m0, 20480
    s_nop 0
    buffer_load_dwordx4 v234, s[8:11], s57 offen nt lds
    s_mov_b32 m0, 21504
    s_mov_b32 s57, 688128
    buffer_load_dwordx4 v232, s[8:11], s57 offen nt lds
    s_mov_b32 m0, 22528
    s_nop 0
    buffer_load_dwordx4 v233, s[8:11], s57 offen nt lds
    s_mov_b32 m0, 23552
    s_nop 0
    buffer_load_dwordx4 v234, s[8:11], s57 offen nt lds
    s_mov_b32 m0, 24576
    s_mov_b32 s57, 786432
    buffer_load_dwordx4 v232, s[8:11], s57 offen nt lds
    s_mov_b32 m0, 25600
    s_nop 0
    buffer_load_dwordx4 v233, s[8:11], s57 offen nt lds
    s_mov_b32 m0, 26624
    s_nop 0
    buffer_load_dwordx4 v234, s[8:11], s57 offen nt lds
    s_mov_b32 m0, 27648
    s_mov_b32 s57, 884736
    buffer_load_dwordx4 v232, s[8:11], s57 offen nt lds
    s_mov_b32 m0, 28672
    s_nop 0
    buffer_load_dwordx4 v233, s[8:11], s57 offen nt lds
    s_mov_b32 m0, 29696
    s_nop 0
    buffer_load_dwordx4 v234, s[8:11], s57 offen nt lds
    s_barrier
    s_mov_b32 s75, s6
    s_lshl_b32 s78, s75, 2
    s_add_u32 s78, s78, s73
    s_lshl_b32 s68, s75, 5
    s_add_u32 s68, s68, s5
    s_sub_u32 s68, s68, 160
    s_cmp_ge_u32 s75, 5
    s_cselect_b32 s78, s68, s78
    s_lshl_b32 s79, s5, 2
    s_cmp_eq_u32 s75, 0
    s_cselect_b32 s79, s79, -1
    s_cmp_eq_u32 s74, 4
    s_cselect_b32 s68, 36, -1
    s_cmp_eq_u32 s74, 2
    s_cselect_b32 s68, 32, s68
    s_cmp_eq_u32 s75, 2
    s_cselect_b32 s68, s68, -1
    s_add_u32 s69, s68, s73
    s_lshl_b32 s69, s69, 2
    s_cmp_lg_u32 s68, -1
    s_cselect_b32 s79, s69, s79
    s_add_u32 s77, s5, 20
    s_cmp_eq_u32 s75, 1
    s_cselect_b32 s77, s77, -1
    s_cmp_eq_u32 s74, 6
    s_cselect_b32 s68, 56, -1
    s_cmp_eq_u32 s74, 0
    s_cselect_b32 s68, 52, s68
    s_cmp_eq_u32 s75, 3
    s_cselect_b32 s68, s68, -1
    s_add_u32 s69, s68, s73
    s_cmp_lg_u32 s68, -1
    s_cselect_b32 s77, s69, s77
    s_sub_u32 s68, s75, 4
    s_lshl_b32 s76, s68, 5
    s_add_u32 s76, s76, s5
    s_cmp_lt_u32 s76, 80
    s_cselect_b32 s76, s76, -1
    s_lshl_b32 s68, s75, 2
    s_lshr_b32 s72, 0x44411155, s68
    s_and_b32 s72, s72, 15
    s_cmp_lg_u32 s77, -1
    s_cselect_b32 s72, 5, s72
    s_cmp_lg_u32 s79, -1
    s_cselect_b32 s72, 5, s72
    s_waitcnt lgkmcnt(0)
    s_add_u32 s4, s4, 1
    v_lshlrev_b32 v8, 8, v11
    v_lshl_add_u32 v8, v15, 4, v8
    v_lshlrev_b32 v9, 8, v3
    v_lshl_add_u32 v9, v2, 4, v9
    v_add_u32 v9, 4096, v9
    v_lshrrev_b32 v7, 2, v1
    v_mul_u32_u24 v7, 384, v7
    v_lshl_add_u32 v7, v15, 3, v7
    v_mov_b32 v254, s4
    s_getreg_b32 s40, hwreg(HW_REG_XCC_ID, 0, 4)
    v_mov_b32 v252, s40
    s_lshl_b32 s56, s74, 9
    s_add_u32 s56, s56, 65536
    s_lshr_b32 s7, s2, 3
    s_lshl_b32 s7, s7, 4
    s_add_u32 s7, s7, s56
    s_mov_b64 exec, 1
    buffer_store_dwordx4 v[252:255], off, s[44:47], s7 sc1
    s_mov_b64 exec, -1
    s_waitcnt vmcnt(31)
    v_dot2_f32_bf16 v240, v16, s26, 0
    v_dot2_f32_bf16 v242, v16, v16, 0
    v_dot2_f32_bf16 v241, v17, s26, 0
    v_dot2_f32_bf16 v243, v17, v17, 0
    v_dot2_f32_bf16 v240, v18, s26, v240
    v_dot2_f32_bf16 v242, v18, v18, v242
    v_dot2_f32_bf16 v241, v19, s26, v241
    v_dot2_f32_bf16 v243, v19, v19, v243
    v_dot2_f32_bf16 v240, v20, s26, v240
    v_dot2_f32_bf16 v242, v20, v20, v242
    v_dot2_f32_bf16 v241, v21, s26, v241
    v_dot2_f32_bf16 v243, v21, v21, v243
    v_dot2_f32_bf16 v240, v22, s26, v240
    v_dot2_f32_bf16 v242, v22, v22, v242
    v_dot2_f32_bf16 v241, v23, s26, v241
    v_dot2_f32_bf16 v243, v23, v23, v243
    v_dot2_f32_bf16 v240, v24, s26, v240
    v_dot2_f32_bf16 v242, v24, v24, v242
    v_dot2_f32_bf16 v241, v25, s26, v241
    v_dot2_f32_bf16 v243, v25, v25, v243
    v_dot2_f32_bf16 v240, v26, s26, v240
    v_dot2_f32_bf16 v242, v26, v26, v242
    v_dot2_f32_bf16 v241, v27, s26, v241
    v_dot2_f32_bf16 v243, v27, v27, v243
    v_dot2_f32_bf16 v240, v28, s26, v240
    v_dot2_f32_bf16 v242, v28, v28, v242
    v_dot2_f32_bf16 v241, v29, s26, v241
    v_dot2_f32_bf16 v243, v29, v29, v243
    v_dot2_f32_bf16 v240, v30, s26, v240
    v_dot2_f32_bf16 v242, v30, v30, v242
    v_dot2_f32_bf16 v241, v31, s26, v241
    v_dot2_f32_bf16 v243, v31, v31, v243
    v_dot2_f32_bf16 v240, v32, s26, v240
    v_dot2_f32_bf16 v242, v32, v32, v242
    v_dot2_f32_bf16 v241, v33, s26, v241
    v_dot2_f32_bf16 v243, v33, v33, v243
    v_dot2_f32_bf16 v240, v34, s26, v240
    v_dot2_f32_bf16 v242, v34, v34, v242
    v_dot2_f32_bf16 v241, v35, s26, v241
    v_dot2_f32_bf16 v243, v35, v35, v243
    s_nop 1
    v_add_f32 v240, v240, v241
    v_add_f32 v242, v242, v243
    s_nop 0
    v_add_f32_dpp v240, v240, v240 row_ror:4 row_mask:0xf bank_mask:0xf
    v_add_f32_dpp v242, v242, v242 row_ror:4 row_mask:0xf bank_mask:0xf
    s_nop 0
    v_add_f32_dpp v240, v240, v240 row_ror:8 row_mask:0xf bank_mask:0xf
    v_add_f32_dpp v242, v242, v242 row_ror:8 row_mask:0xf bank_mask:0xf
    s_nop 1
    v_permlane16_swap_b32 v240, v242
    v_add_f32 v240, v240, v242
    v_mov_b32 v242, v240
    s_nop 1
    v_permlane32_swap_b32 v240, v242
    v_add_f32 v240, v240, v242
    v_mov_b32 v242, v240
    s_nop 1
    v_permlane16_swap_b32 v240, v242
    v_mul_f32 v240, 0xbacccccd, v240
    v_mul_f32 v242, 0x3acccccd, v242
    v_fma_f32 v242, -v240, v240, v242
    v_max_f32 v242, 0, v242
    v_cvt_pk_bf16_f32 v241, v240, v242
    v_lshlrev_b32 v244, 16, v241
    v_and_b32 v242, s53, v241
    v_add_f32 v242, 0x3727c5ac, v242
    v_cvt_pk_bf16_f32 v242, v242, v242
    v_and_b32 v242, s53, v242
    v_sqrt_f32 v242, v242
    s_nop 0
    v_cvt_pk_bf16_f32 v242, v242, v242
    v_and_b32 v242, s53, v242
    v_rcp_f32 v246, v242
    s_waitcnt vmcnt(0)
    ds_read_b64_tr_b16 v[16:17], v7 offset:0
    ds_read_b64_tr_b16 v[20:21], v7 offset:32
    ds_read_b64_tr_b16 v[24:25], v7 offset:64
    ds_read_b64_tr_b16 v[28:29], v7 offset:96
    ds_read_b64_tr_b16 v[32:33], v7 offset:128
    ds_read_b64_tr_b16 v[36:37], v7 offset:160
    ds_read_b64_tr_b16 v[40:41], v7 offset:192
    ds_read_b64_tr_b16 v[44:45], v7 offset:224
    ds_read_b64_tr_b16 v[48:49], v7 offset:256
    ds_read_b64_tr_b16 v[52:53], v7 offset:288
    ds_read_b64_tr_b16 v[56:57], v7 offset:320
    ds_read_b64_tr_b16 v[60:61], v7 offset:352
    ds_read_b64_tr_b16 v[18:19], v7 offset:6144
    ds_read_b64_tr_b16 v[22:23], v7 offset:6176
    ds_read_b64_tr_b16 v[26:27], v7 offset:6208
    ds_read_b64_tr_b16 v[30:31], v7 offset:6240
    ds_read_b64_tr_b16 v[34:35], v7 offset:6272
    ds_read_b64_tr_b16 v[38:39], v7 offset:6304
    ds_read_b64_tr_b16 v[42:43], v7 offset:6336
    ds_read_b64_tr_b16 v[46:47], v7 offset:6368
    ds_read_b64_tr_b16 v[50:51], v7 offset:6400
    ds_read_b64_tr_b16 v[54:55], v7 offset:6432
    ds_read_b64_tr_b16 v[58:59], v7 offset:6464
    ds_read_b64_tr_b16 v[62:63], v7 offset:6496
    ds_read_b64_tr_b16 v[64:65], v7 offset:12288
    ds_read_b64_tr_b16 v[68:69], v7 offset:12320
    ds_read_b64_tr_b16 v[72:73], v7 offset:12352
    ds_read_b64_tr_b16 v[76:77], v7 offset:12384
    ds_read_b64_tr_b16 v[80:81], v7 offset:12416
    ds_read_b64_tr_b16 v[84:85], v7 offset:12448
    ds_read_b64_tr_b16 v[88:89], v7 offset:12480
    ds_read_b64_tr_b16 v[92:93], v7 offset:12512
    ds_read_b64_tr_b16 v[96:97], v7 offset:12544
    ds_read_b64_tr_b16 v[100:101], v7 offset:12576
    ds_read_b64_tr_b16 v[104:105], v7 offset:12608
    ds_read_b64_tr_b16 v[108:109], v7 offset:12640
    ds_read_b64_tr_b16 v[66:67], v7 offset:18432
    ds_read_b64_tr_b16 v[70:71], v7 offset:18464
    ds_read_b64_tr_b16 v[74:75], v7 offset:18496
    ds_read_b64_tr_b16 v[78:79], v7 offset:18528
    ds_read_b64_tr_b16 v[82:83], v7 offset:18560
    ds_read_b64_tr_b16 v[86:87], v7 offset:18592
    ds_read_b64_tr_b16 v[90:91], v7 offset:18624
    ds_read_b64_tr_b16 v[94:95], v7 offset:18656
    ds_read_b64_tr_b16 v[98:99], v7 offset:18688
    ds_read_b64_tr_b16 v[102:103], v7 offset:18720
    ds_read_b64_tr_b16 v[106:107], v7 offset:18752
    ds_read_b64_tr_b16 v[110:111], v7 offset:18784
    ds_read_b64_tr_b16 v[112:113], v7 offset:24576
    ds_read_b64_tr_b16 v[114:115], v7 offset:24608
    ds_read_b64_tr_b16 v[116:117], v7 offset:24640
    ds_read_b64_tr_b16 v[118:119], v7 offset:24672
    ds_read_b64_tr_b16 v[120:121], v7 offset:24704
    ds_read_b64_tr_b16 v[122:123], v7 offset:24736
    ds_read_b64_tr_b16 v[124:125], v7 offset:24768
    ds_read_b64_tr_b16 v[126:127], v7 offset:24800
    ds_read_b64_tr_b16 v[128:129], v7 offset:24832
    ds_read_b64_tr_b16 v[130:131], v7 offset:24864
    ds_read_b64_tr_b16 v[132:133], v7 offset:24896
    ds_read_b64_tr_b16 v[134:135], v7 offset:24928
    v_lshlrev_b32 v10, 4, v1
    s_mov_b32 s50, s56
    buffer_load_dwordx3 v[232:234], v10, s[44:47], s50 offen sc1
    s_mov_b32 s61, 0xffffff00
    s_mov_b32 s62, 0x0c0c0400
    s_mov_b32 s63, 0x04000c0c
    s_mov_b32 s64, 0x07060500
    s_mov_b32 s65, 0x07060501
    s_mov_b32 s66, 0x07060502
    s_mov_b32 s67, 0x07060503
    s_mul_i32 s56, s6, 5120
    s_add_u32 s56, s56, 917504
    s_add_u32 s57, s56, 40960
L_gp_107:
    buffer_load_dwordx4 v[136:139], v8, s[44:47], s56 offen offset:0 sc1
    buffer_load_dwordx4 v[140:143], v8, s[44:47], s56 offen offset:64 sc1
    buffer_load_dwordx4 v[144:147], v8, s[44:47], s56 offen offset:128 sc1
    buffer_load_dwordx4 v[148:151], v8, s[44:47], s56 offen offset:192 sc1
    buffer_load_dwordx4 v[152:155], v8, s[44:47], s57 offen offset:0 sc1
    buffer_load_dwordx4 v[156:159], v8, s[44:47], s57 offen offset:64 sc1
    buffer_load_dwordx4 v[160:163], v8, s[44:47], s57 offen offset:128 sc1
    buffer_load_dwordx4 v[164:167], v8, s[44:47], s57 offen offset:192 sc1
    buffer_load_dwordx4 v[168:171], v9, s[44:47], s56 offen offset:0 sc1
    buffer_load_dwordx4 v[172:175], v9, s[44:47], s57 offen offset:0 sc1
    s_waitcnt vmcnt(9)
    v_perm_b32 v252, v137, v136, s62
    v_perm_b32 v253, v139, v138, s63
    v_bitop3_b32 v12, v252, v253, v254 bitop3:0x56
    s_waitcnt vmcnt(8)
    v_perm_b32 v252, v141, v140, s62
    v_perm_b32 v253, v143, v142, s63
    v_bitop3_b32 v13, v252, v253, v254 bitop3:0x56
    v_or_b32 v12, v12, v13
    s_waitcnt vmcnt(7)
    v_perm_b32 v252, v145, v144, s62
    v_perm_b32 v253, v147, v146, s63
    v_bitop3_b32 v13, v252, v253, v254 bitop3:0x56
    v_or_b32 v12, v12, v13
    s_waitcnt vmcnt(6)
    v_perm_b32 v252, v149, v148, s62
    v_perm_b32 v253, v151, v150, s63
    v_bitop3_b32 v13, v252, v253, v254 bitop3:0x56
    v_or_b32 v12, v12, v13
    s_waitcnt vmcnt(5)
    v_perm_b32 v252, v153, v152, s62
    v_perm_b32 v253, v155, v154, s63
    v_bitop3_b32 v13, v252, v253, v254 bitop3:0x56
    v_or_b32 v12, v12, v13
    s_waitcnt vmcnt(4)
    v_perm_b32 v252, v157, v156, s62
    v_perm_b32 v253, v159, v158, s63
    v_bitop3_b32 v13, v252, v253, v254 bitop3:0x56
    v_or_b32 v12, v12, v13
    s_waitcnt vmcnt(3)
    v_perm_b32 v252, v161, v160, s62
    v_perm_b32 v253, v163, v162, s63
    v_bitop3_b32 v13, v252, v253, v254 bitop3:0x56
    v_or_b32 v12, v12, v13
    s_waitcnt vmcnt(2)
    v_perm_b32 v252, v165, v164, s62
    v_perm_b32 v253, v167, v166, s63
    v_bitop3_b32 v13, v252, v253, v254 bitop3:0x56
    v_or_b32 v12, v12, v13
    s_waitcnt vmcnt(1)
    v_perm_b32 v252, v169, v168, s62
    v_perm_b32 v253, v171, v170, s63
    v_bitop3_b32 v13, v252, v253, v254 bitop3:0x56
    v_or_b32 v12, v12, v13
    s_waitcnt vmcnt(0)
    v_perm_b32 v252, v173, v172, s62
    v_perm_b32 v253, v175, v174, s63
    v_bitop3_b32 v13, v252, v253, v254 bitop3:0x56
    v_or_b32 v12, v12, v13
    v_cmp_ne_u32 vcc, 0, v12
    s_cbranch_vccz L_gpd_108
    s_mov_b64 exec, vcc
    s_sub_u32 s52, s52, 1
    s_cbranch_scc1 L_timeout
    s_sleep 4
    s_branch L_gp_107
L_gpd_108:
    s_mov_b64 exec, -1
    v_and_b32 v136, s61, v136
    v_and_b32 v137, s61, v137
    v_and_b32 v138, s61, v138
    v_and_b32 v139, s61, v139
    v_and_b32 v140, s61, v140
    v_and_b32 v141, s61, v141
    v_and_b32 v142, s61, v142
    v_and_b32 v143, s61, v143
    v_and_b32 v144, s61, v144
    v_and_b32 v145, s61, v145
    v_and_b32 v146, s61, v146
    v_and_b32 v147, s61, v147
    v_and_b32 v148, s61, v148
    v_and_b32 v149, s61, v149
    v_and_b32 v150, s61, v150
    v_and_b32 v151, s61, v151
    v_and_b32 v152, s61, v152
    v_and_b32 v153, s61, v153
    v_and_b32 v154, s61, v154
    v_and_b32 v155, s61, v155
    v_and_b32 v156, s61, v156
    v_and_b32 v157, s61, v157
    v_and_b32 v158, s61, v158
    v_and_b32 v159, s61, v159
    v_and_b32 v160, s61, v160
    v_and_b32 v161, s61, v161
    v_and_b32 v162, s61, v162
    v_and_b32 v163, s61, v163
    v_and_b32 v164, s61, v164
    v_and_b32 v165, s61, v165
    v_and_b32 v166, s61, v166
    v_and_b32 v167, s61, v167
    v_and_b32 v168, s61, v168
    v_and_b32 v169, s61, v169
    v_and_b32 v170, s61, v170
    v_and_b32 v171, s61, v171
    v_and_b32 v172, s61, v172
    v_and_b32 v173, s61, v173
    v_and_b32 v174, s61, v174
    v_and_b32 v175, s61, v175
    s_mov_b32 exec_hi, 0
    v_cmp_ne_u32 vcc, s4, v234
    s_cbranch_vccz L_idok
    s_mov_b32 s60, 0xffffffff
    s_mov_b32 s61, 0x0
L_gm_109:
    s_mov_b64 exec, s[60:61]
    buffer_load_dwordx3 v[232:234], v10, s[44:47], s50 offen offset:0 sc1
    s_waitcnt vmcnt(0)
    s_mov_b64 exec, s[60:61]
    v_cmp_ne_u32 s[60:61], s4, v234
    s_mov_b64 exec, -1
    s_or_b64 s[58:59], s[60:61], s[60:61]
    s_cbranch_scc0 L_gmd_110
    s_sub_u32 s52, s52, 1
    s_cbranch_scc1 L_timeout
    s_sleep 1
    s_branch L_gm_109
L_gmd_110:
    s_mov_b32 s61, 0xffffff00
    s_mov_b32 s62, 0x0c0c0400
    s_mov_b32 s63, 0x04000c0c
    s_mov_b32 s64, 0x07060500
    s_mov_b32 s65, 0x07060501
    s_mov_b32 s66, 0x07060502
    s_mov_b32 s67, 0x07060503
    s_mov_b32 exec_hi, 0
L_idok:
    v_cmp_ne_u32 vcc, s40, v232
    s_mov_b64 exec, -1
    s_cmp_eq_u64 vcc, 0
    s_cselect_b32 s40, 1, 0
    v_pk_add_f32 v[136:137], v[136:137], v[140:141]
    v_pk_add_f32 v[144:145], v[144:145], v[148:149]
    v_pk_add_f32 v[138:139], v[138:139], v[142:143]
    v_pk_add_f32 v[146:147], v[146:147], v[150:151]
    v_pk_add_f32 v[152:153], v[152:153], v[156:157]
    v_pk_add_f32 v[160:161], v[160:161], v[164:165]
    v_pk_add_f32 v[154:155], v[154:155], v[158:159]
    v_pk_add_f32 v[162:163], v[162:163], v[166:167]
    v_add_f32_dpp v168, v168, v168 row_ror:4 row_mask:0xf bank_mask:0xf
    v_add_f32_dpp v169, v169, v169 row_ror:4 row_mask:0xf bank_mask:0xf
    v_add_f32_dpp v170, v170, v170 row_ror:4 row_mask:0xf bank_mask:0xf
    v_add_f32_dpp v171, v171, v171 row_ror:4 row_mask:0xf bank_mask:0xf
    v_add_f32_dpp v172, v172, v172 row_ror:4 row_mask:0xf bank_mask:0xf
    v_add_f32_dpp v173, v173, v173 row_ror:4 row_mask:0xf bank_mask:0xf
    v_add_f32_dpp v174, v174, v174 row_ror:4 row_mask:0xf bank_mask:0xf
    v_add_f32_dpp v175, v175, v175 row_ror:4 row_mask:0xf bank_mask:0xf
    v_pk_add_f32 v[136:137], v[136:137], v[144:145]
    v_pk_add_f32 v[138:139], v[138:139], v[146:147]
    v_pk_add_f32 v[152:153], v[152:153], v[160:161]
    v_pk_add_f32 v[154:155], v[154:155], v[162:163]
    v_add_f32_dpp v168, v168, v168 row_ror:8 row_mask:0xf bank_mask:0xf
    v_add_f32_dpp v169, v169, v169 row_ror:8 row_mask:0xf bank_mask:0xf
    v_add_f32_dpp v170, v170, v170 row_ror:8 row_mask:0xf bank_mask:0xf
    v_add_f32_dpp v171, v171, v171 row_ror:8 row_mask:0xf bank_mask:0xf
    v_add_f32_dpp v172, v172, v172 row_ror:8 row_mask:0xf bank_mask:0xf
    v_add_f32_dpp v173, v173, v173 row_ror:8 row_mask:0xf bank_mask:0xf
    v_add_f32_dpp v174, v174, v174 row_ror:8 row_mask:0xf bank_mask:0xf
    v_add_f32_dpp v175, v175, v175 row_ror:8 row_mask:0xf bank_mask:0xf
    v_cvt_pk_bf16_f32 v236, v136, v137
    v_cvt_pk_bf16_f32 v237, v138, v139
    v_lshlrev_b32 v136, 16, v236
    v_and_b32 v137, s53, v236
    v_lshlrev_b32 v138, 16, v237
    v_and_b32 v139, s53, v237
    v_cvt_pk_bf16_f32 v236, v168, v169
    v_cvt_pk_bf16_f32 v237, v170, v171
    v_lshlrev_b32 v168, 16, v236
    v_and_b32 v169, s53, v236
    v_lshlrev_b32 v170, 16, v237
    v_and_b32 v171, s53, v237
    v_cvt_pk_bf16_f32 v236, v152, v153
    v_cvt_pk_bf16_f32 v237, v154, v155
    v_lshlrev_b32 v152, 16, v236
    v_and_b32 v153, s53, v236
    v_lshlrev_b32 v154, 16, v237
    v_and_b32 v155, s53, v237
    v_add_f32 v152, 1.0, v152
    v_add_f32 v153, 1.0, v153
    v_add_f32 v154, 1.0, v154
    v_add_f32 v155, 1.0, v155
    v_cvt_pk_bf16_f32 v236, v152, v153
    v_cvt_pk_bf16_f32 v237, v154, v155
    v_lshlrev_b32 v152, 16, v236
    v_and_b32 v153, s53, v236
    v_lshlrev_b32 v154, 16, v237
    v_and_b32 v155, s53, v237
    v_cvt_pk_bf16_f32 v236, v172, v173
    v_cvt_pk_bf16_f32 v237, v174, v175
    v_lshlrev_b32 v172, 16, v236
    v_and_b32 v173, s53, v236
    v_lshlrev_b32 v174, 16, v237
    v_and_b32 v175, s53, v237
    v_add_f32 v172, 1.0, v172
    v_add_f32 v173, 1.0, v173
    v_add_f32 v174, 1.0, v174
    v_add_f32 v175, 1.0, v175
    v_cvt_pk_bf16_f32 v236, v172, v173
    v_cvt_pk_bf16_f32 v237, v174, v175
    v_lshlrev_b32 v172, 16, v236
    v_and_b32 v173, s53, v236
    v_lshlrev_b32 v174, 16, v237
    v_and_b32 v175, s53, v237
    v_lshlrev_b32 v248, 16, v228
    v_and_b32 v249, s53, v228
    v_lshlrev_b32 v250, 16, v229
    v_and_b32 v251, s53, v229
    v_pk_add_f32 v[248:249], v[248:249], v[244:245] op_sel_hi:[1,0]
    v_pk_add_f32 v[250:251], v[250:251], v[244:245] op_sel_hi:[1,0]
    v_cvt_pk_bf16_f32 v140, v248, v249
    v_cvt_pk_bf16_f32 v141, v250, v251
    v_lshlrev_b32 v248, 16, v140
    v_and_b32 v249, s53, v140
    v_lshlrev_b32 v250, 16, v141
    v_and_b32 v251, s53, v141
    v_pk_mul_f32 v[248:249], v[248:249], v[246:247] op_sel_hi:[1,0]
    v_pk_mul_f32 v[250:251], v[250:251], v[246:247] op_sel_hi:[1,0]
    v_cvt_pk_bf16_f32 v140, v248, v249
    v_cvt_pk_bf16_f32 v141, v250, v251
    v_lshlrev_b32 v248, 16, v140
    v_and_b32 v249, s53, v140
    v_lshlrev_b32 v250, 16, v141
    v_and_b32 v251, s53, v141
    v_pk_mul_f32 v[248:249], v[248:249], v[152:153]
    v_pk_mul_f32 v[250:251], v[250:251], v[154:155]
    v_cvt_pk_bf16_f32 v140, v248, v249
    v_cvt_pk_bf16_f32 v141, v250, v251
    v_lshlrev_b32 v248, 16, v140
    v_and_b32 v249, s53, v140
    v_lshlrev_b32 v250, 16, v141
    v_and_b32 v251, s53, v141
    v_pk_add_f32 v[248:249], v[248:249], v[136:137]
    v_pk_add_f32 v[250:251], v[250:251], v[138:139]
    v_cvt_pk_bf16_f32 v140, v248, v249
    v_cvt_pk_bf16_f32 v141, v250, v251
    v_lshlrev_b32 v232, 16, v230
    v_and_b32 v233, s53, v230
    v_lshlrev_b32 v234, 16, v231
    v_and_b32 v235, s53, v231
    v_pk_add_f32 v[232:233], v[232:233], v[244:245] op_sel_hi:[1,0]
    v_pk_add_f32 v[234:235], v[234:235], v[244:245] op_sel_hi:[1,0]
    v_cvt_pk_bf16_f32 v148, v232, v233
    v_cvt_pk_bf16_f32 v149, v234, v235
    v_lshlrev_b32 v232, 16, v148
    v_and_b32 v233, s53, v148
    v_lshlrev_b32 v234, 16, v149
    v_and_b32 v235, s53, v149
    v_pk_mul_f32 v[232:233], v[232:233], v[246:247] op_sel_hi:[1,0]
    v_pk_mul_f32 v[234:235], v[234:235], v[246:247] op_sel_hi:[1,0]
    v_cvt_pk_bf16_f32 v148, v232, v233
    v_cvt_pk_bf16_f32 v149, v234, v235
    v_lshlrev_b32 v232, 16, v148
    v_and_b32 v233, s53, v148
    v_lshlrev_b32 v234, 16, v149
    v_and_b32 v235, s53, v149
    v_pk_mul_f32 v[232:233], v[232:233], v[172:173]
    v_pk_mul_f32 v[234:235], v[234:235], v[174:175]
    v_cvt_pk_bf16_f32 v148, v232, v233
    v_cvt_pk_bf16_f32 v149, v234, v235
    v_lshlrev_b32 v232, 16, v148
    v_and_b32 v233, s53, v148
    v_lshlrev_b32 v234, 16, v149
    v_and_b32 v235, s53, v149
    v_pk_add_f32 v[232:233], v[232:233], v[168:169]
    v_pk_add_f32 v[234:235], v[234:235], v[170:171]
    v_cvt_pk_bf16_f32 v148, v232, v233
    v_cvt_pk_bf16_f32 v149, v234, v235
    v_mov_b32_dpp v142, v140 row_shl:4 row_mask:0xf bank_mask:0xf
    v_mov_b32_dpp v143, v141 row_shl:4 row_mask:0xf bank_mask:0xf
    v_mov_b32_dpp v144, v140 row_shl:8 row_mask:0xf bank_mask:0xf
    v_mov_b32_dpp v145, v141 row_shl:8 row_mask:0xf bank_mask:0xf
    v_mov_b32_dpp v146, v140 row_shl:12 row_mask:0xf bank_mask:0xf
    v_mov_b32_dpp v147, v141 row_shl:12 row_mask:0xf bank_mask:0xf
    s_waitcnt lgkmcnt(0)
    v_mfma_f32_16x16x16_bf16 v[176:179], v[112:113], v[148:149], 0
    v_mfma_f32_16x16x16_bf16 v[180:183], v[114:115], v[148:149], 0
    v_mfma_f32_16x16x16_bf16 v[184:187], v[116:117], v[148:149], 0
    v_mfma_f32_16x16x16_bf16 v[188:191], v[118:119], v[148:149], 0
    v_mfma_f32_16x16x16_bf16 v[192:195], v[120:121], v[148:149], 0
    v_mfma_f32_16x16x16_bf16 v[196:199], v[122:123], v[148:149], 0
    v_mfma_f32_16x16x16_bf16 v[200:203], v[124:125], v[148:149], 0
    v_mfma_f32_16x16x16_bf16 v[204:207], v[126:127], v[148:149], 0
    v_mfma_f32_16x16x16_bf16 v[208:211], v[128:129], v[148:149], 0
    v_mfma_f32_16x16x16_bf16 v[212:215], v[130:131], v[148:149], 0
    v_mfma_f32_16x16x16_bf16 v[216:219], v[132:133], v[148:149], 0
    v_mfma_f32_16x16x16_bf16 v[220:223], v[134:135], v[148:149], 0
    v_mfma_f32_16x16x32_bf16 v[176:179], v[16:19], v[140:143], v[176:179]
    v_mul_u32_u24 v9, 6144, v2
    v_lshl_add_u32 v9, v3, 4, v9
    s_mul_i32 s56, s5, 24576
    s_mul_i32 s7, s6, 768
    s_add_u32 s56, s56, s7
    s_add_u32 s56, s56, 1048576
    v_mfma_f32_16x16x32_bf16 v[180:183], v[20:23], v[140:143], v[180:183]
    v_mfma_f32_16x16x32_bf16 v[184:187], v[24:27], v[140:143], v[184:187]
    v_mfma_f32_16x16x32_bf16 v[188:191], v[28:31], v[140:143], v[188:191]
    v_mfma_f32_16x16x32_bf16 v[192:195], v[32:35], v[140:143], v[192:195]
    v_mfma_f32_16x16x32_bf16 v[196:199], v[36:39], v[140:143], v[196:199]
    v_mfma_f32_16x16x32_bf16 v[200:203], v[40:43], v[140:143], v[200:203]
    v_mfma_f32_16x16x32_bf16 v[204:207], v[44:47], v[140:143], v[204:207]
    v_mfma_f32_16x16x32_bf16 v[208:211], v[48:51], v[140:143], v[208:211]
    v_mfma_f32_16x16x32_bf16 v[212:215], v[52:55], v[140:143], v[212:215]
    v_mfma_f32_16x16x32_bf16 v[216:219], v[56:59], v[140:143], v[216:219]
    v_mfma_f32_16x16x32_bf16 v[220:223], v[60:63], v[140:143], v[220:223]
    v_mfma_f32_16x16x32_bf16 v[176:179], v[64:67], v[144:147], v[176:179]
    v_mfma_f32_16x16x32_bf16 v[180:183], v[68:71], v[144:147], v[180:183]
    v_mfma_f32_16x16x32_bf16 v[184:187], v[72:75], v[144:147], v[184:187]
    v_mfma_f32_16x16x32_bf16 v[188:191], v[76:79], v[144:147], v[188:191]
    v_mfma_f32_16x16x32_bf16 v[192:195], v[80:83], v[144:147], v[192:195]
    v_mfma_f32_16x16x32_bf16 v[196:199], v[84:87], v[144:147], v[196:199]
    v_mfma_f32_16x16x32_bf16 v[200:203], v[88:91], v[144:147], v[200:203]
    v_mfma_f32_16x16x32_bf16 v[204:207], v[92:95], v[144:147], v[204:207]
    v_mfma_f32_16x16x32_bf16 v[208:211], v[96:99], v[144:147], v[208:211]
    v_mfma_f32_16x16x32_bf16 v[212:215], v[100:103], v[144:147], v[212:215]
    v_mfma_f32_16x16x32_bf16 v[216:219], v[104:107], v[144:147], v[216:219]
    v_mfma_f32_16x16x32_bf16 v[220:223], v[108:111], v[144:147], v[220:223]
    s_mov_b32 exec_lo, 0x000f000f
    s_mov_b32 exec_hi, 0x000f000f
    s_cmp_eq_u32 s40, 0
    s_cbranch_scc1 L_s2_111
    v_add_u32 v176, 0x80, v176
    v_add_u32 v177, 0x80, v177
    v_add_u32 v178, 0x80, v178
    v_add_u32 v179, 0x80, v179
    v_perm_b32 v176, v176, v254, s64
    v_perm_b32 v177, v177, v254, s65
    v_perm_b32 v178, v178, v254, s66
    v_perm_b32 v179, v179, v254, s67
    buffer_store_dwordx4 v[176:179], v9, s[44:47], s56 offen offset:0
    v_add_u32 v180, 0x80, v180
    v_add_u32 v181, 0x80, v181
    v_add_u32 v182, 0x80, v182
    v_add_u32 v183, 0x80, v183
    v_perm_b32 v180, v180, v254, s64
    v_perm_b32 v181, v181, v254, s65
    v_perm_b32 v182, v182, v254, s66
    v_perm_b32 v183, v183, v254, s67
    buffer_store_dwordx4 v[180:183], v9, s[44:47], s56 offen offset:64
    v_add_u32 v184, 0x80, v184
    v_add_u32 v185, 0x80, v185
    v_add_u32 v186, 0x80, v186
    v_add_u32 v187, 0x80, v187
    v_perm_b32 v184, v184, v254, s64
    v_perm_b32 v185, v185, v254, s65
    v_perm_b32 v186, v186, v254, s66
    v_perm_b32 v187, v187, v254, s67
    buffer_store_dwordx4 v[184:187], v9, s[44:47], s56 offen offset:128
    v_add_u32 v188, 0x80, v188
    v_add_u32 v189, 0x80, v189
    v_add_u32 v190, 0x80, v190
    v_add_u32 v191, 0x80, v191
    v_perm_b32 v188, v188, v254, s64
    v_perm_b32 v189, v189, v254, s65
    v_perm_b32 v190, v190, v254, s66
    v_perm_b32 v191, v191, v254, s67
    buffer_store_dwordx4 v[188:191], v9, s[44:47], s56 offen offset:192
    v_add_u32 v192, 0x80, v192
    v_add_u32 v193, 0x80, v193
    v_add_u32 v194, 0x80, v194
    v_add_u32 v195, 0x80, v195
    v_perm_b32 v192, v192, v254, s64
    v_perm_b32 v193, v193, v254, s65
    v_perm_b32 v194, v194, v254, s66
    v_perm_b32 v195, v195, v254, s67
    buffer_store_dwordx4 v[192:195], v9, s[44:47], s56 offen offset:256
    v_add_u32 v196, 0x80, v196
    v_add_u32 v197, 0x80, v197
    v_add_u32 v198, 0x80, v198
    v_add_u32 v199, 0x80, v199
    v_perm_b32 v196, v196, v254, s64
    v_perm_b32 v197, v197, v254, s65
    v_perm_b32 v198, v198, v254, s66
    v_perm_b32 v199, v199, v254, s67
    buffer_store_dwordx4 v[196:199], v9, s[44:47], s56 offen offset:320
    v_add_u32 v200, 0x80, v200
    v_add_u32 v201, 0x80, v201
    v_add_u32 v202, 0x80, v202
    v_add_u32 v203, 0x80, v203
    v_perm_b32 v200, v200, v254, s64
    v_perm_b32 v201, v201, v254, s65
    v_perm_b32 v202, v202, v254, s66
    v_perm_b32 v203, v203, v254, s67
    buffer_store_dwordx4 v[200:203], v9, s[44:47], s56 offen offset:384
    v_add_u32 v204, 0x80, v204
    v_add_u32 v205, 0x80, v205
    v_add_u32 v206, 0x80, v206
    v_add_u32 v207, 0x80, v207
    v_perm_b32 v204, v204, v254, s64
    v_perm_b32 v205, v205, v254, s65
    v_perm_b32 v206, v206, v254, s66
    v_perm_b32 v207, v207, v254, s67
    buffer_store_dwordx4 v[204:207], v9, s[44:47], s56 offen offset:448
    v_add_u32 v208, 0x80, v208
    v_add_u32 v209, 0x80, v209
    v_add_u32 v210, 0x80, v210
    v_add_u32 v211, 0x80, v211
    v_perm_b32 v208, v208, v254, s64
    v_perm_b32 v209, v209, v254, s65
    v_perm_b32 v210, v210, v254, s66
    v_perm_b32 v211, v211, v254, s67
    buffer_store_dwordx4 v[208:211], v9, s[44:47], s56 offen offset:512
    v_add_u32 v212, 0x80, v212
    v_add_u32 v213, 0x80, v213
    v_add_u32 v214, 0x80, v214
    v_add_u32 v215, 0x80, v215
    v_perm_b32 v212, v212, v254, s64
    v_perm_b32 v213, v213, v254, s65
    v_perm_b32 v214, v214, v254, s66
    v_perm_b32 v215, v215, v254, s67
    buffer_store_dwordx4 v[212:215], v9, s[44:47], s56 offen offset:576
    v_add_u32 v216, 0x80, v216
    v_add_u32 v217, 0x80, v217
    v_add_u32 v218, 0x80, v218
    v_add_u32 v219, 0x80, v219
    v_perm_b32 v216, v216, v254, s64
    v_perm_b32 v217, v217, v254, s65
    v_perm_b32 v218, v218, v254, s66
    v_perm_b32 v219, v219, v254, s67
    buffer_store_dwordx4 v[216:219], v9, s[44:47], s56 offen offset:640
    v_add_u32 v220, 0x80, v220
    v_add_u32 v221, 0x80, v221
    v_add_u32 v222, 0x80, v222
    v_add_u32 v223, 0x80, v223
    v_perm_b32 v220, v220, v254, s64
    v_perm_b32 v221, v221, v254, s65
    v_perm_b32 v222, v222, v254, s66
    v_perm_b32 v223, v223, v254, s67
    buffer_store_dwordx4 v[220:223], v9, s[44:47], s56 offen offset:704
    s_branch L_s2e_112
L_s2_111:
    s_nop 7
    v_add_u32 v176, 0x80, v176
    v_add_u32 v177, 0x80, v177
    v_add_u32 v178, 0x80, v178
    v_add_u32 v179, 0x80, v179
    v_perm_b32 v176, v176, v254, s64
    v_perm_b32 v177, v177, v254, s65
    v_perm_b32 v178, v178, v254, s66
    v_perm_b32 v179, v179, v254, s67
    buffer_store_dwordx4 v[176:179], v9, s[44:47], s56 offen offset:0 sc1
    v_add_u32 v180, 0x80, v180
    v_add_u32 v181, 0x80, v181
    v_add_u32 v182, 0x80, v182
    v_add_u32 v183, 0x80, v183
    v_perm_b32 v180, v180, v254, s64
    v_perm_b32 v181, v181, v254, s65
    v_perm_b32 v182, v182, v254, s66
    v_perm_b32 v183, v183, v254, s67
    buffer_store_dwordx4 v[180:183], v9, s[44:47], s56 offen offset:64 sc1
    v_add_u32 v184, 0x80, v184
    v_add_u32 v185, 0x80, v185
    v_add_u32 v186, 0x80, v186
    v_add_u32 v187, 0x80, v187
    v_perm_b32 v184, v184, v254, s64
    v_perm_b32 v185, v185, v254, s65
    v_perm_b32 v186, v186, v254, s66
    v_perm_b32 v187, v187, v254, s67
    buffer_store_dwordx4 v[184:187], v9, s[44:47], s56 offen offset:128 sc1
    v_add_u32 v188, 0x80, v188
    v_add_u32 v189, 0x80, v189
    v_add_u32 v190, 0x80, v190
    v_add_u32 v191, 0x80, v191
    v_perm_b32 v188, v188, v254, s64
    v_perm_b32 v189, v189, v254, s65
    v_perm_b32 v190, v190, v254, s66
    v_perm_b32 v191, v191, v254, s67
    buffer_store_dwordx4 v[188:191], v9, s[44:47], s56 offen offset:192 sc1
    v_add_u32 v192, 0x80, v192
    v_add_u32 v193, 0x80, v193
    v_add_u32 v194, 0x80, v194
    v_add_u32 v195, 0x80, v195
    v_perm_b32 v192, v192, v254, s64
    v_perm_b32 v193, v193, v254, s65
    v_perm_b32 v194, v194, v254, s66
    v_perm_b32 v195, v195, v254, s67
    buffer_store_dwordx4 v[192:195], v9, s[44:47], s56 offen offset:256 sc1
    v_add_u32 v196, 0x80, v196
    v_add_u32 v197, 0x80, v197
    v_add_u32 v198, 0x80, v198
    v_add_u32 v199, 0x80, v199
    v_perm_b32 v196, v196, v254, s64
    v_perm_b32 v197, v197, v254, s65
    v_perm_b32 v198, v198, v254, s66
    v_perm_b32 v199, v199, v254, s67
    buffer_store_dwordx4 v[196:199], v9, s[44:47], s56 offen offset:320 sc1
    v_add_u32 v200, 0x80, v200
    v_add_u32 v201, 0x80, v201
    v_add_u32 v202, 0x80, v202
    v_add_u32 v203, 0x80, v203
    v_perm_b32 v200, v200, v254, s64
    v_perm_b32 v201, v201, v254, s65
    v_perm_b32 v202, v202, v254, s66
    v_perm_b32 v203, v203, v254, s67
    buffer_store_dwordx4 v[200:203], v9, s[44:47], s56 offen offset:384 sc1
    v_add_u32 v204, 0x80, v204
    v_add_u32 v205, 0x80, v205
    v_add_u32 v206, 0x80, v206
    v_add_u32 v207, 0x80, v207
    v_perm_b32 v204, v204, v254, s64
    v_perm_b32 v205, v205, v254, s65
    v_perm_b32 v206, v206, v254, s66
    v_perm_b32 v207, v207, v254, s67
    buffer_store_dwordx4 v[204:207], v9, s[44:47], s56 offen offset:448 sc1
    v_add_u32 v208, 0x80, v208
    v_add_u32 v209, 0x80, v209
    v_add_u32 v210, 0x80, v210
    v_add_u32 v211, 0x80, v211
    v_perm_b32 v208, v208, v254, s64
    v_perm_b32 v209, v209, v254, s65
    v_perm_b32 v210, v210, v254, s66
    v_perm_b32 v211, v211, v254, s67
    buffer_store_dwordx4 v[208:211], v9, s[44:47], s56 offen offset:512 sc1
    v_add_u32 v212, 0x80, v212
    v_add_u32 v213, 0x80, v213
    v_add_u32 v214, 0x80, v214
    v_add_u32 v215, 0x80, v215
    v_perm_b32 v212, v212, v254, s64
    v_perm_b32 v213, v213, v254, s65
    v_perm_b32 v214, v214, v254, s66
    v_perm_b32 v215, v215, v254, s67
    buffer_store_dwordx4 v[212:215], v9, s[44:47], s56 offen offset:576 sc1
    v_add_u32 v216, 0x80, v216
    v_add_u32 v217, 0x80, v217
    v_add_u32 v218, 0x80, v218
    v_add_u32 v219, 0x80, v219
    v_perm_b32 v216, v216, v254, s64
    v_perm_b32 v217, v217, v254, s65
    v_perm_b32 v218, v218, v254, s66
    v_perm_b32 v219, v219, v254, s67
    buffer_store_dwordx4 v[216:219], v9, s[44:47], s56 offen offset:640 sc1
    v_add_u32 v220, 0x80, v220
    v_add_u32 v221, 0x80, v221
    v_add_u32 v222, 0x80, v222
    v_add_u32 v223, 0x80, v223
    v_perm_b32 v220, v220, v254, s64
    v_perm_b32 v221, v221, v254, s65
    v_perm_b32 v222, v222, v254, s66
    v_perm_b32 v223, v223, v254, s67
    buffer_store_dwordx4 v[220:223], v9, s[44:47], s56 offen offset:704 sc1
L_s2e_112:
    s_mul_i32 s56, s5, 24576
    s_add_u32 s56, s56, 1048576
    s_mov_b64 exec, -1
    v_lshlrev_b32 v8, 4, v1
    v_add_u32 v9, 3072, v8
    v_lshlrev_b32 v10, 3, v1
    v_add_u32 v10, 144640, v10
    v_mov_b32 v15, s40
    ds_write_b32 v14, v15 offset:0
    s_mov_b32 s50, 0
L_qg:
    s_mov_b32 exec_hi, 0xffff
L_gp_113:
    buffer_load_dwordx4 v[16:19], v8, s[44:47], s56 offen offset:0 sc1
    buffer_load_dwordx4 v[20:23], v8, s[44:47], s56 offen offset:768 sc1
    buffer_load_dwordx4 v[24:27], v8, s[44:47], s56 offen offset:1536 sc1
    buffer_load_dwordx4 v[28:31], v8, s[44:47], s56 offen offset:2304 sc1
    buffer_load_dwordx4 v[32:35], v9, s[44:47], s56 offen offset:0 sc1
    buffer_load_dwordx4 v[36:39], v9, s[44:47], s56 offen offset:768 sc1
    buffer_load_dwordx4 v[40:43], v9, s[44:47], s56 offen offset:1536 sc1
    buffer_load_dwordx4 v[44:47], v9, s[44:47], s56 offen offset:2304 sc1
    s_waitcnt vmcnt(7)
    v_perm_b32 v252, v17, v16, s62
    v_perm_b32 v253, v19, v18, s63
    v_bitop3_b32 v12, v252, v253, v254 bitop3:0x56
    s_waitcnt vmcnt(6)
    v_perm_b32 v252, v21, v20, s62
    v_perm_b32 v253, v23, v22, s63
    v_bitop3_b32 v13, v252, v253, v254 bitop3:0x56
    v_or_b32 v12, v12, v13
    s_waitcnt vmcnt(5)
    v_perm_b32 v252, v25, v24, s62
    v_perm_b32 v253, v27, v26, s63
    v_bitop3_b32 v13, v252, v253, v254 bitop3:0x56
    v_or_b32 v12, v12, v13
    s_waitcnt vmcnt(4)
    v_perm_b32 v252, v29, v28, s62
    v_perm_b32 v253, v31, v30, s63
    v_bitop3_b32 v13, v252, v253, v254 bitop3:0x56
    v_or_b32 v12, v12, v13
    s_waitcnt vmcnt(3)
    v_perm_b32 v252, v33, v32, s62
    v_perm_b32 v253, v35, v34, s63
    v_bitop3_b32 v13, v252, v253, v254 bitop3:0x56
    v_or_b32 v12, v12, v13
    s_waitcnt vmcnt(2)
    v_perm_b32 v252, v37, v36, s62
    v_perm_b32 v253, v39, v38, s63
    v_bitop3_b32 v13, v252, v253, v254 bitop3:0x56
    v_or_b32 v12, v12, v13
    s_waitcnt vmcnt(1)
    v_perm_b32 v252, v41, v40, s62
    v_perm_b32 v253, v43, v42, s63
    v_bitop3_b32 v13, v252, v253, v254 bitop3:0x56
    v_or_b32 v12, v12, v13
    s_waitcnt vmcnt(0)
    v_perm_b32 v252, v45, v44, s62
    v_perm_b32 v253, v47, v46, s63
    v_bitop3_b32 v13, v252, v253, v254 bitop3:0x56
    v_or_b32 v12, v12, v13
    v_cmp_ne_u32 vcc, 0, v12
    s_cbranch_vccz L_gpd_114
    s_mov_b64 exec, vcc
    s_sub_u32 s52, s52, 1
    s_cbranch_scc1 L_timeout
    s_sleep 4
    s_branch L_gp_113
L_gpd_114:
    s_mov_b32 exec_lo, -1
    s_mov_b32 exec_hi, 0xffff
    v_and_b32 v16, s61, v16
    v_and_b32 v17, s61, v17
    v_and_b32 v18, s61, v18
    v_and_b32 v19, s61, v19
    v_and_b32 v20, s61, v20
    v_and_b32 v21, s61, v21
    v_and_b32 v22, s61, v22
    v_and_b32 v23, s61, v23
    v_and_b32 v24, s61, v24
    v_and_b32 v25, s61, v25
    v_and_b32 v26, s61, v26
    v_and_b32 v27, s61, v27
    v_and_b32 v28, s61, v28
    v_and_b32 v29, s61, v29
    v_and_b32 v30, s61, v30
    v_and_b32 v31, s61, v31
    v_and_b32 v32, s61, v32
    v_and_b32 v33, s61, v33
    v_and_b32 v34, s61, v34
    v_and_b32 v35, s61, v35
    v_and_b32 v36, s61, v36
    v_and_b32 v37, s61, v37
    v_and_b32 v38, s61, v38
    v_and_b32 v39, s61, v39
    v_and_b32 v40, s61, v40
    v_and_b32 v41, s61, v41
    v_and_b32 v42, s61, v42
    v_and_b32 v43, s61, v43
    v_and_b32 v44, s61, v44
    v_and_b32 v45, s61, v45
    v_and_b32 v46, s61, v46
    v_and_b32 v47, s61, v47
    v_pk_add_f32 v[16:17], v[16:17], v[20:21]
    v_pk_add_f32 v[18:19], v[18:19], v[22:23]
    v_pk_add_f32 v[24:25], v[24:25], v[28:29]
    v_pk_add_f32 v[26:27], v[26:27], v[30:31]
    v_pk_add_f32 v[32:33], v[32:33], v[36:37]
    v_pk_add_f32 v[34:35], v[34:35], v[38:39]
    v_pk_add_f32 v[40:41], v[40:41], v[44:45]
    v_pk_add_f32 v[42:43], v[42:43], v[46:47]
    v_pk_add_f32 v[16:17], v[16:17], v[24:25]
    v_pk_add_f32 v[18:19], v[18:19], v[26:27]
    v_pk_add_f32 v[32:33], v[32:33], v[40:41]
    v_pk_add_f32 v[34:35], v[34:35], v[42:43]
    v_pk_add_f32 v[16:17], v[16:17], v[32:33]
    v_pk_add_f32 v[18:19], v[18:19], v[34:35]
    v_cvt_pk_bf16_f32 v84, v16, v17
    v_cvt_pk_bf16_f32 v85, v18, v19
    ds_write_b64 v10, v[84:85]
    s_add_u32 s50, s50, 1
    v_mov_b32 v15, s50
    ds_write_b32 v14, v15 offset:4
    s_mov_b64 exec, -1
    v_add_u32 v10, 384, v10
    s_add_u32 s56, s56, 6144
    s_cmp_lt_u32 s50, 4
    s_cbranch_scc1 L_qg
L_lw_115:
    ds_read_b32 v13, v14 offset:24
    s_waitcnt lgkmcnt(0)
    v_readfirstlane_b32 s7, v13
    s_nop 0
    s_cmp_ge_u32 s7, 12
    s_cbranch_scc1 L_lwd_116
    s_sub_u32 s52, s52, 1
    s_cbranch_scc1 L_timeout
    s_sleep 16
    s_branch L_lw_115
L_lwd_116:
    v_mov_b32 v8, 0
    s_mov_b32 s56, 73728
    s_mov_b32 s60, 0x1
    s_mov_b32 s61, 0x0
L_gm_117:
    s_mov_b64 exec, s[60:61]
    buffer_load_dwordx3 v[88:90], v8, s[44:47], s56 offen offset:0 sc1
    s_waitcnt vmcnt(0)
    s_mov_b64 exec, s[60:61]
    v_cmp_ne_u32 s[60:61], s4, v90
    s_mov_b64 exec, -1
    s_or_b64 s[58:59], s[60:61], s[60:61]
    s_cbranch_scc0 L_gmd_118
    s_sub_u32 s52, s52, 1
    s_cbranch_scc1 L_timeout
    s_sleep 16
    s_branch L_gm_117
L_gmd_118:
    s_mov_b64 exec, 1
    v_add_u32 v88, 1, v88
    ds_write_b32 v14, v88 offset:28
    s_mov_b64 exec, -1
    s_branch L_prep
L_w56:
    s_sub_u32 s58, s3, 5
    s_barrier
    s_mov_b32 s75, s6
    s_lshl_b32 s78, s75, 2
    s_add_u32 s78, s78, s73
    s_lshl_b32 s68, s75, 5
    s_add_u32 s68, s68, s5
    s_sub_u32 s68, s68, 160
    s_cmp_ge_u32 s75, 5
    s_cselect_b32 s78, s68, s78
    s_lshl_b32 s79, s5, 2
    s_cmp_eq_u32 s75, 0
    s_cselect_b32 s79, s79, -1
    s_cmp_eq_u32 s74, 4
    s_cselect_b32 s68, 36, -1
    s_cmp_eq_u32 s74, 2
    s_cselect_b32 s68, 32, s68
    s_cmp_eq_u32 s75, 2
    s_cselect_b32 s68, s68, -1
    s_add_u32 s69, s68, s73
    s_lshl_b32 s69, s69, 2
    s_cmp_lg_u32 s68, -1
    s_cselect_b32 s79, s69, s79
    s_add_u32 s77, s5, 20
    s_cmp_eq_u32 s75, 1
    s_cselect_b32 s77, s77, -1
    s_cmp_eq_u32 s74, 6
    s_cselect_b32 s68, 56, -1
    s_cmp_eq_u32 s74, 0
    s_cselect_b32 s68, 52, s68
    s_cmp_eq_u32 s75, 3
    s_cselect_b32 s68, s68, -1
    s_add_u32 s69, s68, s73
    s_cmp_lg_u32 s68, -1
    s_cselect_b32 s77, s69, s77
    s_sub_u32 s68, s75, 4
    s_lshl_b32 s76, s68, 5
    s_add_u32 s76, s76, s5
    s_cmp_lt_u32 s76, 80
    s_cselect_b32 s76, s76, -1
    s_lshl_b32 s68, s75, 2
    s_lshr_b32 s72, 0x44411155, s68
    s_and_b32 s72, s72, 15
    s_cmp_lg_u32 s77, -1
    s_cselect_b32 s72, 5, s72
    s_cmp_lg_u32 s79, -1
    s_cselect_b32 s72, 5, s72
    s_waitcnt lgkmcnt(0)
    s_add_u32 s4, s4, 1
    s_cmp_lg_u32 s3, 5
    s_cbranch_scc1 L_nomeas
    s_cmp_lg_u32 s2, 97
    s_cbranch_scc1 L_nomeas
    s_add_u32 s68, s42, 3145728
    s_addc_u32 s69, s43, 0
    s_mov_b32 s62, -1
    s_mov_b32 s63, -1
    s_mov_b32 s56, 12
L_meas:
    s_memtime s[64:65]
    s_waitcnt lgkmcnt(0)
    s_load_dword s60, s[68:69], 0x0 glc
    s_waitcnt lgkmcnt(0)
    s_memtime s[66:67]
    s_waitcnt lgkmcnt(0)
    s_sub_u32 s66, s66, s64
    s_min_u32 s62, s62, s66
    s_memtime s[64:65]
    s_waitcnt lgkmcnt(0)
    s_load_dword s60, s[68:69], 0x2000 glc
    s_waitcnt lgkmcnt(0)
    s_memtime s[66:67]
    s_waitcnt lgkmcnt(0)
    s_sub_u32 s66, s66, s64
    s_min_u32 s63, s63, s66
    s_sub_u32 s56, s56, 1
    s_cmp_lg_u32 s56, 0
    s_cbranch_scc1 L_meas
    s_cmp_ge_u32 s62, s63
    s_cselect_b32 s7, 1, 0
    v_mov_b32 v16, s7
    v_mov_b32 v18, s4
    s_mov_b32 s7, 73728
    s_mov_b64 exec, 1
    buffer_store_dwordx4 v[16:19], off, s[44:47], s7 sc1
    s_mov_b64 exec, -1
L_nomeas:
    s_cmp_eq_u32 s77, -1
    s_cbranch_scc1 L_w56n
L_lw_119:
    ds_read_b32 v15, v14 offset:20
    s_waitcnt lgkmcnt(0)
    v_readfirstlane_b32 s7, v15
    s_nop 0
    s_cmp_ge_u32 s7, 1
    s_cbranch_scc1 L_lwd_120
    s_sub_u32 s52, s52, 1
    s_cbranch_scc1 L_timeout
    s_sleep 4
    s_branch L_lw_119
L_lwd_120:
    s_mov_b32 s48, s34
    s_mov_b32 s49, s35
    s_mov_b32 s50, 5120
    s_mov_b32 s51, 0x20000
    v_and_b32 v15, 3, v1
    v_mul_u32_u24 v9, 1280, v15
    v_lshrrev_b32 v10, 2, v1
    v_lshl_add_u32 v9, v10, 4, v9
    s_mul_i32 s7, s58, 640
    buffer_load_dwordx4 v[16:19], v9, s[48:51], s7 offen offset:0
    buffer_load_dwordx4 v[20:23], v9, s[48:51], s7 offen offset:256
    buffer_load_dwordx4 v[24:27], v9, s[48:51], s7 offen offset:512
    s_lshl_b32 s7, s77, 7
    s_add_u32 s8, s36, s7
    s_addc_u32 s9, s37, 0
    s_mov_b32 s10, 4907648
    s_mov_b32 s11, 0x20000
    v_lshrrev_b32 v8, 3, v1
    v_mul_u32_u24 v8, 7680, v8
    v_and_b32 v11, 7, v1
    v_lshl_add_u32 v8, v11, 4, v8
    s_mul_i32 s57, s58, 2457600
    s_mul_i32 s56, s58, 40960
    s_add_u32 s56, s56, 30720
    s_mov_b32 m0, s56
    s_nop 0
    buffer_load_dwordx4 v8, s[8:11], s57 offen nt lds
    s_add_u32 m0, m0, 1024
    s_add_u32 s57, s57, 61440
    buffer_load_dwordx4 v8, s[8:11], s57 offen nt lds
    s_add_u32 m0, m0, 1024
    s_add_u32 s57, s57, 61440
    buffer_load_dwordx4 v8, s[8:11], s57 offen nt lds
    s_add_u32 m0, m0, 1024
    s_add_u32 s57, s57, 61440
    buffer_load_dwordx4 v8, s[8:11], s57 offen nt lds
    s_add_u32 m0, m0, 1024
    s_add_u32 s57, s57, 61440
    buffer_load_dwordx4 v8, s[8:11], s57 offen nt lds
    s_add_u32 m0, m0, 1024
    s_add_u32 s57, s57, 61440
    buffer_load_dwordx4 v8, s[8:11], s57 offen nt lds
    s_add_u32 m0, m0, 1024
    s_add_u32 s57, s57, 61440
    buffer_load_dwordx4 v8, s[8:11], s57 offen nt lds
    s_add_u32 m0, m0, 1024
    s_add_u32 s57, s57, 61440
    buffer_load_dwordx4 v8, s[8:11], s57 offen nt lds
    s_add_u32 m0, m0, 1024
    s_add_u32 s57, s57, 61440
    s_waitcnt vmcnt(7)
    buffer_load_dwordx4 v8, s[8:11], s57 offen nt lds
    s_add_u32 m0, m0, 1024
    s_add_u32 s57, s57, 61440
    s_waitcnt vmcnt(7)
    buffer_load_dwordx4 v8, s[8:11], s57 offen nt lds
    s_add_u32 m0, m0, 1024
    s_add_u32 s57, s57, 61440
    s_waitcnt vmcnt(7)
    buffer_load_dwordx4 v8, s[8:11], s57 offen nt lds
    s_add_u32 m0, m0, 1024
    s_add_u32 s57, s57, 61440
    s_waitcnt vmcnt(7)
    buffer_load_dwordx4 v8, s[8:11], s57 offen nt lds
    s_add_u32 m0, m0, 1024
    s_add_u32 s57, s57, 61440
    s_waitcnt vmcnt(7)
    buffer_load_dwordx4 v8, s[8:11], s57 offen nt lds
    s_add_u32 m0, m0, 1024
    s_add_u32 s57, s57, 61440
    s_waitcnt vmcnt(7)
    buffer_load_dwordx4 v8, s[8:11], s57 offen nt lds
    s_add_u32 m0, m0, 1024
    s_add_u32 s57, s57, 61440
    s_waitcnt vmcnt(7)
    buffer_load_dwordx4 v8, s[8:11], s57 offen nt lds
    s_add_u32 m0, m0, 1024
    s_add_u32 s57, s57, 61440
    s_waitcnt vmcnt(7)
    buffer_load_dwordx4 v8, s[8:11], s57 offen nt lds
    s_add_u32 m0, m0, 1024
    s_add_u32 s57, s57, 61440
    s_waitcnt vmcnt(7)
    buffer_load_dwordx4 v8, s[8:11], s57 offen nt lds
    s_add_u32 m0, m0, 1024
    s_add_u32 s57, s57, 61440
    s_waitcnt vmcnt(7)
    buffer_load_dwordx4 v8, s[8:11], s57 offen nt lds
    s_add_u32 m0, m0, 1024
    s_add_u32 s57, s57, 61440
    s_waitcnt vmcnt(7)
    buffer_load_dwordx4 v8, s[8:11], s57 offen nt lds
    s_add_u32 m0, m0, 1024
    s_add_u32 s57, s57, 61440
    s_waitcnt vmcnt(7)
    buffer_load_dwordx4 v8, s[8:11], s57 offen nt lds
    s_add_u32 m0, m0, 1024
    s_add_u32 s57, s57, 61440
    s_waitcnt vmcnt(7)
    buffer_load_dwordx4 v8, s[8:11], s57 offen nt lds
    s_add_u32 m0, m0, 1024
    s_add_u32 s57, s57, 61440
    s_waitcnt vmcnt(7)
    buffer_load_dwordx4 v8, s[8:11], s57 offen nt lds
    s_add_u32 m0, m0, 1024
    s_add_u32 s57, s57, 61440
    s_waitcnt vmcnt(7)
    buffer_load_dwordx4 v8, s[8:11], s57 offen nt lds
    s_add_u32 m0, m0, 1024
    s_add_u32 s57, s57, 61440
    s_waitcnt vmcnt(7)
    buffer_load_dwordx4 v8, s[8:11], s57 offen nt lds
    s_add_u32 m0, m0, 1024
    s_add_u32 s57, s57, 61440
    s_waitcnt vmcnt(7)
    buffer_load_dwordx4 v8, s[8:11], s57 offen nt lds
    s_add_u32 m0, m0, 1024
    s_add_u32 s57, s57, 61440
    s_waitcnt vmcnt(7)
    buffer_load_dwordx4 v8, s[8:11], s57 offen nt lds
    s_add_u32 m0, m0, 1024
    s_add_u32 s57, s57, 61440
    s_waitcnt vmcnt(7)
    buffer_load_dwordx4 v8, s[8:11], s57 offen nt lds
    s_add_u32 m0, m0, 1024
    s_add_u32 s57, s57, 61440
    s_waitcnt vmcnt(7)
    buffer_load_dwordx4 v8, s[8:11], s57 offen nt lds
    s_add_u32 m0, m0, 1024
    s_add_u32 s57, s57, 61440
    s_waitcnt vmcnt(7)
    buffer_load_dwordx4 v8, s[8:11], s57 offen nt lds
    s_add_u32 m0, m0, 1024
    s_add_u32 s57, s57, 61440
    s_waitcnt vmcnt(7)
    buffer_load_dwordx4 v8, s[8:11], s57 offen nt lds
    s_add_u32 m0, m0, 1024
    s_add_u32 s57, s57, 61440
    s_waitcnt vmcnt(7)
    buffer_load_dwordx4 v8, s[8:11], s57 offen nt lds
    s_add_u32 m0, m0, 1024
    s_add_u32 s57, s57, 61440
    s_waitcnt vmcnt(7)
    buffer_load_dwordx4 v8, s[8:11], s57 offen nt lds
    s_add_u32 m0, m0, 1024
    s_add_u32 s57, s57, 61440
    s_waitcnt vmcnt(7)
    buffer_load_dwordx4 v8, s[8:11], s57 offen nt lds
    s_add_u32 m0, m0, 1024
    s_add_u32 s57, s57, 61440
    s_waitcnt vmcnt(7)
    buffer_load_dwordx4 v8, s[8:11], s57 offen nt lds
    s_add_u32 m0, m0, 1024
    s_add_u32 s57, s57, 61440
    s_waitcnt vmcnt(7)
    buffer_load_dwordx4 v8, s[8:11], s57 offen nt lds
    s_add_u32 m0, m0, 1024
    s_add_u32 s57, s57, 61440
    s_waitcnt vmcnt(7)
    buffer_load_dwordx4 v8, s[8:11], s57 offen nt lds
    s_add_u32 m0, m0, 1024
    s_add_u32 s57, s57, 61440
    s_waitcnt vmcnt(7)
    buffer_load_dwordx4 v8, s[8:11], s57 offen nt lds
    s_add_u32 m0, m0, 1024
    s_add_u32 s57, s57, 61440
    s_waitcnt vmcnt(7)
    buffer_load_dwordx4 v8, s[8:11], s57 offen nt lds
    s_add_u32 m0, m0, 1024
    s_add_u32 s57, s57, 61440
    s_waitcnt vmcnt(7)
    buffer_load_dwordx4 v8, s[8:11], s57 offen nt lds
    s_add_u32 m0, m0, 1024
    s_add_u32 s57, s57, 61440
    s_waitcnt vmcnt(7)
    buffer_load_dwordx4 v8, s[8:11], s57 offen nt lds
    s_mul_i32 s7, s58, 2560
    s_add_u32 s7, s7, 129024
    v_mul_u32_u24 v9, 640, v15
    v_add_u32 v9, s7, v9
    v_lshl_add_u32 v5, v10, 4, v9
    v_lshl_add_u32 v6, v3, 4, v9
    v_lshrrev_b32 v7, 2, v2
    v_lshl_add_u32 v7, v3, 3, v7
    v_lshlrev_b32 v7, 7, v7
    v_lshl_add_u32 v7, v15, 3, v7
    v_add_u32 v7, s56, v7
    s_waitcnt vmcnt(40)
    v_lshlrev_b32 v216, 16, v16
    v_and_b32 v217, s53, v16
    v_lshlrev_b32 v218, 16, v17
    v_and_b32 v219, s53, v17
    v_lshlrev_b32 v220, 16, v18
    v_and_b32 v221, s53, v18
    v_lshlrev_b32 v222, 16, v19
    v_and_b32 v223, s53, v19
    v_mul_f32 v224, 0xbfb8aa3b, v216
    v_mul_f32 v225, 0xbfb8aa3b, v217
    v_mul_f32 v226, 0xbfb8aa3b, v218
    v_mul_f32 v227, 0xbfb8aa3b, v219
    v_mul_f32 v228, 0xbfb8aa3b, v220
    v_mul_f32 v229, 0xbfb8aa3b, v221
    v_mul_f32 v230, 0xbfb8aa3b, v222
    v_mul_f32 v231, 0xbfb8aa3b, v223
    v_exp_f32 v224, v224
    v_exp_f32 v225, v225
    v_exp_f32 v226, v226
    v_exp_f32 v227, v227
    v_exp_f32 v228, v228
    v_exp_f32 v229, v229
    v_exp_f32 v230, v230
    v_exp_f32 v231, v231
    v_add_f32 v224, 1.0, v224
    v_add_f32 v225, 1.0, v225
    v_add_f32 v226, 1.0, v226
    v_add_f32 v227, 1.0, v227
    v_add_f32 v228, 1.0, v228
    v_add_f32 v229, 1.0, v229
    v_add_f32 v230, 1.0, v230
    v_add_f32 v231, 1.0, v231
    v_rcp_f32 v224, v224
    v_rcp_f32 v225, v225
    v_rcp_f32 v226, v226
    v_rcp_f32 v227, v227
    v_rcp_f32 v228, v228
    v_rcp_f32 v229, v229
    v_rcp_f32 v230, v230
    v_rcp_f32 v231, v231
    v_mul_f32 v216, v216, v224
    v_mul_f32 v217, v217, v225
    v_mul_f32 v218, v218, v226
    v_mul_f32 v219, v219, v227
    v_mul_f32 v220, v220, v228
    v_mul_f32 v221, v221, v229
    v_mul_f32 v222, v222, v230
    v_mul_f32 v223, v223, v231
    v_cvt_pk_bf16_f32 v16, v216, v217
    v_cvt_pk_bf16_f32 v17, v218, v219
    v_cvt_pk_bf16_f32 v18, v220, v221
    v_cvt_pk_bf16_f32 v19, v222, v223
    ds_write_b128 v5, v[16:19] offset:0
    v_lshlrev_b32 v216, 16, v20
    v_and_b32 v217, s53, v20
    v_lshlrev_b32 v218, 16, v21
    v_and_b32 v219, s53, v21
    v_lshlrev_b32 v220, 16, v22
    v_and_b32 v221, s53, v22
    v_lshlrev_b32 v222, 16, v23
    v_and_b32 v223, s53, v23
    v_mul_f32 v224, 0xbfb8aa3b, v216
    v_mul_f32 v225, 0xbfb8aa3b, v217
    v_mul_f32 v226, 0xbfb8aa3b, v218
    v_mul_f32 v227, 0xbfb8aa3b, v219
    v_mul_f32 v228, 0xbfb8aa3b, v220
    v_mul_f32 v229, 0xbfb8aa3b, v221
    v_mul_f32 v230, 0xbfb8aa3b, v222
    v_mul_f32 v231, 0xbfb8aa3b, v223
    v_exp_f32 v224, v224
    v_exp_f32 v225, v225
    v_exp_f32 v226, v226
    v_exp_f32 v227, v227
    v_exp_f32 v228, v228
    v_exp_f32 v229, v229
    v_exp_f32 v230, v230
    v_exp_f32 v231, v231
    v_add_f32 v224, 1.0, v224
    v_add_f32 v225, 1.0, v225
    v_add_f32 v226, 1.0, v226
    v_add_f32 v227, 1.0, v227
    v_add_f32 v228, 1.0, v228
    v_add_f32 v229, 1.0, v229
    v_add_f32 v230, 1.0, v230
    v_add_f32 v231, 1.0, v231
    v_rcp_f32 v224, v224
    v_rcp_f32 v225, v225
    v_rcp_f32 v226, v226
    v_rcp_f32 v227, v227
    v_rcp_f32 v228, v228
    v_rcp_f32 v229, v229
    v_rcp_f32 v230, v230
    v_rcp_f32 v231, v231
    v_mul_f32 v216, v216, v224
    v_mul_f32 v217, v217, v225
    v_mul_f32 v218, v218, v226
    v_mul_f32 v219, v219, v227
    v_mul_f32 v220, v220, v228
    v_mul_f32 v221, v221, v229
    v_mul_f32 v222, v222, v230
    v_mul_f32 v223, v223, v231
    v_cvt_pk_bf16_f32 v20, v216, v217
    v_cvt_pk_bf16_f32 v21, v218, v219
    v_cvt_pk_bf16_f32 v22, v220, v221
    v_cvt_pk_bf16_f32 v23, v222, v223
    ds_write_b128 v5, v[20:23] offset:256
    v_lshlrev_b32 v216, 16, v24
    v_and_b32 v217, s53, v24
    v_lshlrev_b32 v218, 16, v25
    v_and_b32 v219, s53, v25
    v_lshlrev_b32 v220, 16, v26
    v_and_b32 v221, s53, v26
    v_lshlrev_b32 v222, 16, v27
    v_and_b32 v223, s53, v27
    v_mul_f32 v224, 0xbfb8aa3b, v216
    v_mul_f32 v225, 0xbfb8aa3b, v217
    v_mul_f32 v226, 0xbfb8aa3b, v218
    v_mul_f32 v227, 0xbfb8aa3b, v219
    v_mul_f32 v228, 0xbfb8aa3b, v220
    v_mul_f32 v229, 0xbfb8aa3b, v221
    v_mul_f32 v230, 0xbfb8aa3b, v222
    v_mul_f32 v231, 0xbfb8aa3b, v223
    v_exp_f32 v224, v224
    v_exp_f32 v225, v225
    v_exp_f32 v226, v226
    v_exp_f32 v227, v227
    v_exp_f32 v228, v228
    v_exp_f32 v229, v229
    v_exp_f32 v230, v230
    v_exp_f32 v231, v231
    v_add_f32 v224, 1.0, v224
    v_add_f32 v225, 1.0, v225
    v_add_f32 v226, 1.0, v226
    v_add_f32 v227, 1.0, v227
    v_add_f32 v228, 1.0, v228
    v_add_f32 v229, 1.0, v229
    v_add_f32 v230, 1.0, v230
    v_add_f32 v231, 1.0, v231
    v_rcp_f32 v224, v224
    v_rcp_f32 v225, v225
    v_rcp_f32 v226, v226
    v_rcp_f32 v227, v227
    v_rcp_f32 v228, v228
    v_rcp_f32 v229, v229
    v_rcp_f32 v230, v230
    v_rcp_f32 v231, v231
    v_mul_f32 v216, v216, v224
    v_mul_f32 v217, v217, v225
    v_mul_f32 v218, v218, v226
    v_mul_f32 v219, v219, v227
    v_mul_f32 v220, v220, v228
    v_mul_f32 v221, v221, v229
    v_mul_f32 v222, v222, v230
    v_mul_f32 v223, v223, v231
    v_cvt_pk_bf16_f32 v24, v216, v217
    v_cvt_pk_bf16_f32 v25, v218, v219
    v_cvt_pk_bf16_f32 v26, v220, v221
    v_cvt_pk_bf16_f32 v27, v222, v223
    s_mov_b32 exec_hi, 0
    ds_write_b128 v5, v[24:27] offset:512
    s_mov_b64 exec, -1
    s_waitcnt lgkmcnt(0)
    ds_read_b128 v[32:35], v6 offset:0
    ds_read_b128 v[36:39], v6 offset:64
    ds_read_b128 v[40:43], v6 offset:128
    ds_read_b128 v[44:47], v6 offset:192
    ds_read_b128 v[48:51], v6 offset:256
    ds_read_b128 v[52:55], v6 offset:320
    ds_read_b128 v[56:59], v6 offset:384
    ds_read_b128 v[60:63], v6 offset:448
    ds_read_b128 v[64:67], v6 offset:512
    ds_read_b128 v[68:71], v6 offset:576
    s_waitcnt vmcnt(32)
    ds_read_b64_tr_b16 v[72:73], v7 offset:0
    ds_read_b64_tr_b16 v[74:75], v7 offset:512
    ds_read_b64_tr_b16 v[76:77], v7 offset:32
    ds_read_b64_tr_b16 v[78:79], v7 offset:544
    ds_read_b64_tr_b16 v[80:81], v7 offset:64
    ds_read_b64_tr_b16 v[82:83], v7 offset:576
    ds_read_b64_tr_b16 v[84:85], v7 offset:96
    ds_read_b64_tr_b16 v[86:87], v7 offset:608
    ds_read_b64_tr_b16 v[88:89], v7 offset:4096
    ds_read_b64_tr_b16 v[90:91], v7 offset:4608
    ds_read_b64_tr_b16 v[92:93], v7 offset:4128
    ds_read_b64_tr_b16 v[94:95], v7 offset:4640
    ds_read_b64_tr_b16 v[96:97], v7 offset:4160
    ds_read_b64_tr_b16 v[98:99], v7 offset:4672
    ds_read_b64_tr_b16 v[100:101], v7 offset:4192
    ds_read_b64_tr_b16 v[102:103], v7 offset:4704
    s_waitcnt lgkmcnt(8)
    v_mfma_f32_16x16x32_bf16 v[136:139], v[72:75], v[32:35], 0
    v_mfma_f32_16x16x32_bf16 v[140:143], v[76:79], v[32:35], 0
    v_mfma_f32_16x16x32_bf16 v[144:147], v[80:83], v[32:35], 0
    v_mfma_f32_16x16x32_bf16 v[148:151], v[84:87], v[32:35], 0
    s_waitcnt lgkmcnt(0)
    v_mfma_f32_16x16x32_bf16 v[136:139], v[88:91], v[36:39], v[136:139]
    v_mfma_f32_16x16x32_bf16 v[140:143], v[92:95], v[36:39], v[140:143]
    v_mfma_f32_16x16x32_bf16 v[144:147], v[96:99], v[36:39], v[144:147]
    v_mfma_f32_16x16x32_bf16 v[148:151], v[100:103], v[36:39], v[148:151]
    s_waitcnt vmcnt(24)
    ds_read_b64_tr_b16 v[104:105], v7 offset:8192
    ds_read_b64_tr_b16 v[106:107], v7 offset:8704
    ds_read_b64_tr_b16 v[108:109], v7 offset:8224
    ds_read_b64_tr_b16 v[110:111], v7 offset:8736
    ds_read_b64_tr_b16 v[112:113], v7 offset:8256
    ds_read_b64_tr_b16 v[114:115], v7 offset:8768
    ds_read_b64_tr_b16 v[116:117], v7 offset:8288
    ds_read_b64_tr_b16 v[118:119], v7 offset:8800
    ds_read_b64_tr_b16 v[120:121], v7 offset:12288
    ds_read_b64_tr_b16 v[122:123], v7 offset:12800
    ds_read_b64_tr_b16 v[124:125], v7 offset:12320
    ds_read_b64_tr_b16 v[126:127], v7 offset:12832
    ds_read_b64_tr_b16 v[128:129], v7 offset:12352
    ds_read_b64_tr_b16 v[130:131], v7 offset:12864
    ds_read_b64_tr_b16 v[132:133], v7 offset:12384
    ds_read_b64_tr_b16 v[134:135], v7 offset:12896
    s_waitcnt lgkmcnt(8)
    v_mfma_f32_16x16x32_bf16 v[136:139], v[104:107], v[40:43], v[136:139]
    v_mfma_f32_16x16x32_bf16 v[140:143], v[108:111], v[40:43], v[140:143]
    v_mfma_f32_16x16x32_bf16 v[144:147], v[112:115], v[40:43], v[144:147]
    v_mfma_f32_16x16x32_bf16 v[148:151], v[116:119], v[40:43], v[148:151]
    s_waitcnt lgkmcnt(0)
    v_mfma_f32_16x16x32_bf16 v[136:139], v[120:123], v[44:47], v[136:139]
    v_mfma_f32_16x16x32_bf16 v[140:143], v[124:127], v[44:47], v[140:143]
    v_mfma_f32_16x16x32_bf16 v[144:147], v[128:131], v[44:47], v[144:147]
    v_mfma_f32_16x16x32_bf16 v[148:151], v[132:135], v[44:47], v[148:151]
    s_waitcnt vmcnt(16)
    ds_read_b64_tr_b16 v[72:73], v7 offset:16384
    ds_read_b64_tr_b16 v[74:75], v7 offset:16896
    ds_read_b64_tr_b16 v[76:77], v7 offset:16416
    ds_read_b64_tr_b16 v[78:79], v7 offset:16928
    ds_read_b64_tr_b16 v[80:81], v7 offset:16448
    ds_read_b64_tr_b16 v[82:83], v7 offset:16960
    ds_read_b64_tr_b16 v[84:85], v7 offset:16480
    ds_read_b64_tr_b16 v[86:87], v7 offset:16992
    ds_read_b64_tr_b16 v[88:89], v7 offset:20480
    ds_read_b64_tr_b16 v[90:91], v7 offset:20992
    ds_read_b64_tr_b16 v[92:93], v7 offset:20512
    ds_read_b64_tr_b16 v[94:95], v7 offset:21024
    ds_read_b64_tr_b16 v[96:97], v7 offset:20544
    ds_read_b64_tr_b16 v[98:99], v7 offset:21056
    ds_read_b64_tr_b16 v[100:101], v7 offset:20576
    ds_read_b64_tr_b16 v[102:103], v7 offset:21088
    s_waitcnt lgkmcnt(8)
    v_mfma_f32_16x16x32_bf16 v[136:139], v[72:75], v[48:51], v[136:139]
    v_mfma_f32_16x16x32_bf16 v[140:143], v[76:79], v[48:51], v[140:143]
    v_mfma_f32_16x16x32_bf16 v[144:147], v[80:83], v[48:51], v[144:147]
    v_mfma_f32_16x16x32_bf16 v[148:151], v[84:87], v[48:51], v[148:151]
    s_waitcnt lgkmcnt(0)
    v_mfma_f32_16x16x32_bf16 v[136:139], v[88:91], v[52:55], v[136:139]
    v_mfma_f32_16x16x32_bf16 v[140:143], v[92:95], v[52:55], v[140:143]
    v_mfma_f32_16x16x32_bf16 v[144:147], v[96:99], v[52:55], v[144:147]
    v_mfma_f32_16x16x32_bf16 v[148:151], v[100:103], v[52:55], v[148:151]
    s_waitcnt vmcnt(8)
    ds_read_b64_tr_b16 v[104:105], v7 offset:24576
    ds_read_b64_tr_b16 v[106:107], v7 offset:25088
    ds_read_b64_tr_b16 v[108:109], v7 offset:24608
    ds_read_b64_tr_b16 v[110:111], v7 offset:25120
    ds_read_b64_tr_b16 v[112:113], v7 offset:24640
    ds_read_b64_tr_b16 v[114:115], v7 offset:25152
    ds_read_b64_tr_b16 v[116:117], v7 offset:24672
    ds_read_b64_tr_b16 v[118:119], v7 offset:25184
    ds_read_b64_tr_b16 v[120:121], v7 offset:28672
    ds_read_b64_tr_b16 v[122:123], v7 offset:29184
    ds_read_b64_tr_b16 v[124:125], v7 offset:28704
    ds_read_b64_tr_b16 v[126:127], v7 offset:29216
    ds_read_b64_tr_b16 v[128:129], v7 offset:28736
    ds_read_b64_tr_b16 v[130:131], v7 offset:29248
    ds_read_b64_tr_b16 v[132:133], v7 offset:28768
    ds_read_b64_tr_b16 v[134:135], v7 offset:29280
    s_waitcnt lgkmcnt(8)
    v_mfma_f32_16x16x32_bf16 v[136:139], v[104:107], v[56:59], v[136:139]
    v_mfma_f32_16x16x32_bf16 v[140:143], v[108:111], v[56:59], v[140:143]
    v_mfma_f32_16x16x32_bf16 v[144:147], v[112:115], v[56:59], v[144:147]
    v_mfma_f32_16x16x32_bf16 v[148:151], v[116:119], v[56:59], v[148:151]
    s_waitcnt lgkmcnt(0)
    v_mfma_f32_16x16x32_bf16 v[136:139], v[120:123], v[60:63], v[136:139]
    v_mfma_f32_16x16x32_bf16 v[140:143], v[124:127], v[60:63], v[140:143]
    v_mfma_f32_16x16x32_bf16 v[144:147], v[128:131], v[60:63], v[144:147]
    v_mfma_f32_16x16x32_bf16 v[148:151], v[132:135], v[60:63], v[148:151]
    s_waitcnt vmcnt(0)
    ds_read_b64_tr_b16 v[72:73], v7 offset:32768
    ds_read_b64_tr_b16 v[74:75], v7 offset:33280
    ds_read_b64_tr_b16 v[76:77], v7 offset:32800
    ds_read_b64_tr_b16 v[78:79], v7 offset:33312
    ds_read_b64_tr_b16 v[80:81], v7 offset:32832
    ds_read_b64_tr_b16 v[82:83], v7 offset:33344
    ds_read_b64_tr_b16 v[84:85], v7 offset:32864
    ds_read_b64_tr_b16 v[86:87], v7 offset:33376
    ds_read_b64_tr_b16 v[88:89], v7 offset:36864
    ds_read_b64_tr_b16 v[90:91], v7 offset:37376
    ds_read_b64_tr_b16 v[92:93], v7 offset:36896
    ds_read_b64_tr_b16 v[94:95], v7 offset:37408
    ds_read_b64_tr_b16 v[96:97], v7 offset:36928
    ds_read_b64_tr_b16 v[98:99], v7 offset:37440
    ds_read_b64_tr_b16 v[100:101], v7 offset:36960
    ds_read_b64_tr_b16 v[102:103], v7 offset:37472
    s_waitcnt lgkmcnt(8)
    v_mfma_f32_16x16x32_bf16 v[136:139], v[72:75], v[64:67], v[136:139]
    v_mfma_f32_16x16x32_bf16 v[140:143], v[76:79], v[64:67], v[140:143]
    v_mfma_f32_16x16x32_bf16 v[144:147], v[80:83], v[64:67], v[144:147]
    v_mfma_f32_16x16x32_bf16 v[148:151], v[84:87], v[64:67], v[148:151]
    s_waitcnt lgkmcnt(0)
    v_mfma_f32_16x16x32_bf16 v[136:139], v[88:91], v[68:71], v[136:139]
    v_mfma_f32_16x16x32_bf16 v[140:143], v[92:95], v[68:71], v[140:143]
    v_mfma_f32_16x16x32_bf16 v[144:147], v[96:99], v[68:71], v[144:147]
    v_mfma_f32_16x16x32_bf16 v[148:151], v[100:103], v[68:71], v[148:151]
    v_lshlrev_b32 v8, 4, v1
    s_lshl_b32 s7, s58, 10
    s_add_u32 s7, s7, 134144
    v_add_u32 v9, s7, v8
    s_xor_b32 s7, s58, 1
    s_lshl_b32 s7, s7, 10
    s_add_u32 s7, s7, 134144
    v_add_u32 v10, s7, v8
    v_mov_b32 v11, 1
    s_mov_b32 exec_lo, 0xf000f0
    s_mov_b32 exec_hi, 0xf000f0
    v_mov_b32 v136, v140
    v_mov_b32 v137, v141
    v_mov_b32 v138, v142
    v_mov_b32 v139, v143
    s_mov_b32 exec_lo, 0xf000f00
    s_mov_b32 exec_hi, 0xf000f00
    v_mov_b32 v136, v144
    v_mov_b32 v137, v145
    v_mov_b32 v138, v146
    v_mov_b32 v139, v147
    s_mov_b32 exec_lo, 0xf000f000
    s_mov_b32 exec_hi, 0xf000f000
    v_mov_b32 v136, v148
    v_mov_b32 v137, v149
    v_mov_b32 v138, v150
    v_mov_b32 v139, v151
    s_mov_b64 exec, -1
    ds_write_b128 v9, v[136:139]
    s_waitcnt lgkmcnt(0)
    s_mov_b64 exec, 1
    ds_add_rtn_u32 v11, v14, v11 offset:16
    s_mov_b64 exec, -1
    v_and_b32 v8, 12, v2
    v_add_u32 v8, v8, v3
    v_lshlrev_b32 v8, 6, v8
    v_lshl_add_u32 v8, v15, 4, v8
    s_lshl_b32 s56, s77, 10
    s_add_u32 s56, s56, 4096
    v_mov_b32 v146, s4
    s_waitcnt lgkmcnt(0)
    v_readfirstlane_b32 s7, v11
    s_nop 0
    s_cmp_eq_u32 s7, 0
    s_cbranch_scc1 L_prep
    ds_read_b128 v[140:143], v10
    s_waitcnt lgkmcnt(0)
    v_add_f32 v136, v136, v140
    v_add_f32 v137, v137, v141
    v_add_f32 v138, v138, v142
    v_add_f32 v139, v139, v143
    v_cvt_pk_bf16_f32 v144, v136, v137
    v_cvt_pk_bf16_f32 v145, v138, v139
    buffer_store_dwordx4 v[144:147], v8, s[44:47], s56 offen sc1
    s_branch L_prep
L_w56n:
    s_cmp_eq_u32 s79, -1
    s_cbranch_scc1 L_prep
    s_lshl_b32 s7, s79, 3
    s_add_u32 s8, s32, s7
    s_addc_u32 s9, s33, 0
    s_mov_b32 s10, 1964832
    s_mov_b32 s11, 0x20000
    v_lshrrev_b32 v8, 1, v1
    s_mov_b32 s7, 1280
    v_mul_lo_u32 v8, v8, s7
    v_and_b32 v15, 1, v1
    v_lshl_add_u32 v8, v15, 4, v8
L_lw_121:
    ds_read_b32 v15, v14 offset:20
    s_waitcnt lgkmcnt(0)
    v_readfirstlane_b32 s7, v15
    s_nop 0
    s_cmp_ge_u32 s7, 1
    s_cbranch_scc1 L_lwd_122
    s_sub_u32 s52, s52, 1
    s_cbranch_scc1 L_timeout
    s_sleep 4
    s_branch L_lw_121
L_lwd_122:
    s_mul_i32 s56, s58, 24576
    s_add_u32 s56, s56, 79872
    s_mov_b32 m0, s56
    s_mul_i32 s57, s58, 983040
    buffer_load_dwordx4 v8, s[8:11], s57 offen nt lds
    s_add_u32 m0, m0, 1024
    s_add_u32 s57, s57, 40960
    buffer_load_dwordx4 v8, s[8:11], s57 offen nt lds
    s_add_u32 m0, m0, 1024
    s_add_u32 s57, s57, 40960
    s_waitcnt vmcnt(1)
    buffer_load_dwordx4 v8, s[8:11], s57 offen nt lds
    s_add_u32 m0, m0, 1024
    s_add_u32 s57, s57, 40960
    s_waitcnt vmcnt(1)
    buffer_load_dwordx4 v8, s[8:11], s57 offen nt lds
    s_add_u32 m0, m0, 1024
    s_add_u32 s57, s57, 40960
    s_waitcnt vmcnt(1)
    buffer_load_dwordx4 v8, s[8:11], s57 offen nt lds
    s_add_u32 m0, m0, 1024
    s_add_u32 s57, s57, 40960
    s_add_u32 m0, m0, 1024
    s_add_u32 s57, s57, 40960
    s_add_u32 m0, m0, 1024
    s_add_u32 s57, s57, 40960
    s_add_u32 m0, m0, 1024
    s_add_u32 s57, s57, 40960
    s_add_u32 m0, m0, 1024
    s_add_u32 s57, s57, 40960
    s_add_u32 m0, m0, 1024
    s_add_u32 s57, s57, 40960
    s_add_u32 m0, m0, 1024
    s_add_u32 s57, s57, 40960
    s_add_u32 m0, m0, 1024
    s_add_u32 s57, s57, 40960
    s_waitcnt vmcnt(1)
    buffer_load_dwordx4 v8, s[8:11], s57 offen nt lds
    s_add_u32 m0, m0, 1024
    s_add_u32 s57, s57, 40960
    s_waitcnt vmcnt(1)
    buffer_load_dwordx4 v8, s[8:11], s57 offen nt lds
    s_add_u32 m0, m0, 1024
    s_add_u32 s57, s57, 40960
    s_waitcnt vmcnt(1)
    buffer_load_dwordx4 v8, s[8:11], s57 offen nt lds
    s_add_u32 m0, m0, 1024
    s_add_u32 s57, s57, 40960
    s_waitcnt vmcnt(1)
    buffer_load_dwordx4 v8, s[8:11], s57 offen nt lds
    s_add_u32 m0, m0, 1024
    s_add_u32 s57, s57, 40960
    s_waitcnt vmcnt(1)
    buffer_load_dwordx4 v8, s[8:11], s57 offen nt lds
    s_add_u32 m0, m0, 1024
    s_add_u32 s57, s57, 40960
    s_add_u32 m0, m0, 1024
    s_add_u32 s57, s57, 40960
    s_add_u32 m0, m0, 1024
    s_add_u32 s57, s57, 40960
    s_add_u32 m0, m0, 1024
    s_add_u32 s57, s57, 40960
    s_add_u32 m0, m0, 1024
    s_add_u32 s57, s57, 40960
    s_add_u32 m0, m0, 1024
    s_add_u32 s57, s57, 40960
    s_add_u32 m0, m0, 1024
    s_add_u32 s57, s57, 40960
    s_waitcnt vmcnt(0)
    s_mov_b64 exec, 1
    v_mov_b32 v15, 1
    ds_add_u32 v14, v15 offset:12
    s_mov_b64 exec, -1
    s_branch L_prep
L_w7:
    s_sub_u32 s7, s6, 4
    s_lshl_b32 s76, s7, 5
    s_add_u32 s76, s76, s5
    s_cmp_ge_u32 s76, 80
    s_cbranch_scc1 L_w7n
    s_setprio 3
    s_and_b32 s58, s76, 3
    s_lshr_b32 s59, s76, 2
    s_mov_b32 s48, s34
    s_mov_b32 s49, s35
    s_mov_b32 s50, 5120
    s_mov_b32 s51, 0x20000
    v_and_b32 v15, 3, v1
    v_mul_u32_u24 v9, 1280, v15
    v_lshrrev_b32 v10, 2, v1
    v_lshl_add_u32 v9, v10, 4, v9
    s_mul_i32 s7, s58, 320
    buffer_load_dwordx4 v[16:19], v9, s[48:51], s7 offen offset:0
    buffer_load_dwordx4 v[20:23], v9, s[48:51], s7 offen offset:256
    s_lshl_b32 s7, s59, 7
    s_mul_i32 s56, s58, 1228800
    s_add_u32 s7, s7, s56
    s_add_u32 s8, s36, s7
    s_addc_u32 s9, s37, 0
    s_mov_b32 s10, 1221248
    s_mov_b32 s11, 0x20000
    v_lshrrev_b32 v8, 3, v1
    v_mul_u32_u24 v8, 7680, v8
    v_and_b32 v11, 7, v1
    v_lshl_add_u32 v8, v11, 4, v8
    s_mov_b32 m0, 79872
    s_mov_b32 s57, 0
    buffer_load_dwordx4 v8, s[8:11], s57 offen nt lds
    s_mov_b32 m0, 80896
    s_mov_b32 s57, 61440
    buffer_load_dwordx4 v8, s[8:11], s57 offen nt lds
    s_mov_b32 m0, 81920
    s_mov_b32 s57, 122880
    buffer_load_dwordx4 v8, s[8:11], s57 offen nt lds
    s_mov_b32 m0, 82944
    s_mov_b32 s57, 184320
    buffer_load_dwordx4 v8, s[8:11], s57 offen nt lds
    s_mov_b32 m0, 83968
    s_mov_b32 s57, 245760
    buffer_load_dwordx4 v8, s[8:11], s57 offen nt lds
    s_mov_b32 m0, 84992
    s_mov_b32 s57, 307200
    buffer_load_dwordx4 v8, s[8:11], s57 offen nt lds
    s_mov_b32 m0, 86016
    s_mov_b32 s57, 368640
    buffer_load_dwordx4 v8, s[8:11], s57 offen nt lds
    s_mov_b32 m0, 87040
    s_mov_b32 s57, 430080
    buffer_load_dwordx4 v8, s[8:11], s57 offen nt lds
    s_mov_b32 m0, 88064
    s_mov_b32 s57, 491520
    buffer_load_dwordx4 v8, s[8:11], s57 offen nt lds
    s_mov_b32 m0, 89088
    s_mov_b32 s57, 552960
    buffer_load_dwordx4 v8, s[8:11], s57 offen nt lds
    s_mov_b32 m0, 90112
    s_mov_b32 s57, 614400
    buffer_load_dwordx4 v8, s[8:11], s57 offen nt lds
    s_mov_b32 m0, 91136
    s_mov_b32 s57, 675840
    buffer_load_dwordx4 v8, s[8:11], s57 offen nt lds
    s_mov_b32 m0, 92160
    s_mov_b32 s57, 737280
    buffer_load_dwordx4 v8, s[8:11], s57 offen nt lds
    s_mov_b32 m0, 93184
    s_mov_b32 s57, 798720
    buffer_load_dwordx4 v8, s[8:11], s57 offen nt lds
    s_mov_b32 m0, 94208
    s_mov_b32 s57, 860160
    buffer_load_dwordx4 v8, s[8:11], s57 offen nt lds
    s_mov_b32 m0, 95232
    s_mov_b32 s57, 921600
    buffer_load_dwordx4 v8, s[8:11], s57 offen nt lds
    s_mov_b32 m0, 96256
    s_mov_b32 s57, 983040
    buffer_load_dwordx4 v8, s[8:11], s57 offen nt lds
    s_mov_b32 m0, 97280
    s_mov_b32 s57, 1044480
    buffer_load_dwordx4 v8, s[8:11], s57 offen nt lds
    s_mov_b32 m0, 98304
    s_mov_b32 s57, 1105920
    buffer_load_dwordx4 v8, s[8:11], s57 offen nt lds
    s_mov_b32 m0, 99328
    s_mov_b32 s57, 1167360
    buffer_load_dwordx4 v8, s[8:11], s57 offen nt lds
    s_mov_b64 exec, 1
    v_mov_b32 v13, 1
    ds_add_u32 v14, v13 offset:16
    s_mov_b64 exec, -1
    s_barrier
    s_waitcnt lgkmcnt(0)
    s_add_u32 s4, s4, 1
    v_mul_u32_u24 v9, 320, v15
    v_add_u32 v9, 129024, v9
    v_lshl_add_u32 v5, v10, 4, v9
    v_lshl_add_u32 v6, v3, 4, v9
    v_lshrrev_b32 v7, 2, v2
    v_lshl_add_u32 v7, v3, 3, v7
    v_lshlrev_b32 v7, 7, v7
    v_lshl_add_u32 v7, v15, 3, v7
    v_add_u32 v7, 79872, v7
    v_mov_b32 v234, s4
    s_mov_b32 s61, 0xffffff00
    s_mov_b32 s62, 0x0c0c0400
    s_mov_b32 s63, 0x04000c0c
    s_mov_b32 s64, 0x07060500
    s_mov_b32 s65, 0x07060501
    s_mov_b32 s66, 0x07060502
    s_mov_b32 s67, 0x07060503
    v_and_b32 v8, 12, v2
    v_add_u32 v8, v8, v3
    v_lshlrev_b32 v8, 8, v8
    v_lshl_add_u32 v8, v15, 4, v8
    s_lshl_b32 s56, s59, 12
    s_lshl_b32 s7, s58, 6
    s_add_u32 s56, s56, s7
    s_add_u32 s56, s56, 917504
    s_waitcnt vmcnt(20)
    v_lshlrev_b32 v216, 16, v16
    v_and_b32 v217, s53, v16
    v_lshlrev_b32 v218, 16, v17
    v_and_b32 v219, s53, v17
    v_lshlrev_b32 v220, 16, v18
    v_and_b32 v221, s53, v18
    v_lshlrev_b32 v222, 16, v19
    v_and_b32 v223, s53, v19
    v_mul_f32 v224, 0xbfb8aa3b, v216
    v_mul_f32 v225, 0xbfb8aa3b, v217
    v_mul_f32 v226, 0xbfb8aa3b, v218
    v_mul_f32 v227, 0xbfb8aa3b, v219
    v_mul_f32 v228, 0xbfb8aa3b, v220
    v_mul_f32 v229, 0xbfb8aa3b, v221
    v_mul_f32 v230, 0xbfb8aa3b, v222
    v_mul_f32 v231, 0xbfb8aa3b, v223
    v_exp_f32 v224, v224
    v_exp_f32 v225, v225
    v_exp_f32 v226, v226
    v_exp_f32 v227, v227
    v_exp_f32 v228, v228
    v_exp_f32 v229, v229
    v_exp_f32 v230, v230
    v_exp_f32 v231, v231
    v_add_f32 v224, 1.0, v224
    v_add_f32 v225, 1.0, v225
    v_add_f32 v226, 1.0, v226
    v_add_f32 v227, 1.0, v227
    v_add_f32 v228, 1.0, v228
    v_add_f32 v229, 1.0, v229
    v_add_f32 v230, 1.0, v230
    v_add_f32 v231, 1.0, v231
    v_rcp_f32 v224, v224
    v_rcp_f32 v225, v225
    v_rcp_f32 v226, v226
    v_rcp_f32 v227, v227
    v_rcp_f32 v228, v228
    v_rcp_f32 v229, v229
    v_rcp_f32 v230, v230
    v_rcp_f32 v231, v231
    v_mul_f32 v216, v216, v224
    v_mul_f32 v217, v217, v225
    v_mul_f32 v218, v218, v226
    v_mul_f32 v219, v219, v227
    v_mul_f32 v220, v220, v228
    v_mul_f32 v221, v221, v229
    v_mul_f32 v222, v222, v230
    v_mul_f32 v223, v223, v231
    v_cvt_pk_bf16_f32 v16, v216, v217
    v_cvt_pk_bf16_f32 v17, v218, v219
    v_cvt_pk_bf16_f32 v18, v220, v221
    v_cvt_pk_bf16_f32 v19, v222, v223
    ds_write_b128 v5, v[16:19] offset:0
    v_lshlrev_b32 v216, 16, v20
    v_and_b32 v217, s53, v20
    v_lshlrev_b32 v218, 16, v21
    v_and_b32 v219, s53, v21
    v_lshlrev_b32 v220, 16, v22
    v_and_b32 v221, s53, v22
    v_lshlrev_b32 v222, 16, v23
    v_and_b32 v223, s53, v23
    v_mul_f32 v224, 0xbfb8aa3b, v216
    v_mul_f32 v225, 0xbfb8aa3b, v217
    v_mul_f32 v226, 0xbfb8aa3b, v218
    v_mul_f32 v227, 0xbfb8aa3b, v219
    v_mul_f32 v228, 0xbfb8aa3b, v220
    v_mul_f32 v229, 0xbfb8aa3b, v221
    v_mul_f32 v230, 0xbfb8aa3b, v222
    v_mul_f32 v231, 0xbfb8aa3b, v223
    v_exp_f32 v224, v224
    v_exp_f32 v225, v225
    v_exp_f32 v226, v226
    v_exp_f32 v227, v227
    v_exp_f32 v228, v228
    v_exp_f32 v229, v229
    v_exp_f32 v230, v230
    v_exp_f32 v231, v231
    v_add_f32 v224, 1.0, v224
    v_add_f32 v225, 1.0, v225
    v_add_f32 v226, 1.0, v226
    v_add_f32 v227, 1.0, v227
    v_add_f32 v228, 1.0, v228
    v_add_f32 v229, 1.0, v229
    v_add_f32 v230, 1.0, v230
    v_add_f32 v231, 1.0, v231
    v_rcp_f32 v224, v224
    v_rcp_f32 v225, v225
    v_rcp_f32 v226, v226
    v_rcp_f32 v227, v227
    v_rcp_f32 v228, v228
    v_rcp_f32 v229, v229
    v_rcp_f32 v230, v230
    v_rcp_f32 v231, v231
    v_mul_f32 v216, v216, v224
    v_mul_f32 v217, v217, v225
    v_mul_f32 v218, v218, v226
    v_mul_f32 v219, v219, v227
    v_mul_f32 v220, v220, v228
    v_mul_f32 v221, v221, v229
    v_mul_f32 v222, v222, v230
    v_mul_f32 v223, v223, v231
    v_cvt_pk_bf16_f32 v20, v216, v217
    v_cvt_pk_bf16_f32 v21, v218, v219
    v_cvt_pk_bf16_f32 v22, v220, v221
    v_cvt_pk_bf16_f32 v23, v222, v223
    s_mov_b64 exec, 0xffff
    ds_write_b128 v5, v[20:23] offset:256
    s_mov_b64 exec, -1
    s_waitcnt lgkmcnt(0)
    ds_read_b128 v[32:35], v6 offset:0
    ds_read_b128 v[36:39], v6 offset:64
    ds_read_b128 v[40:43], v6 offset:128
    ds_read_b128 v[44:47], v6 offset:192
    ds_read_b128 v[48:51], v6 offset:256
    s_waitcnt vmcnt(16)
    ds_read_b64_tr_b16 v[72:73], v7 offset:0
    ds_read_b64_tr_b16 v[74:75], v7 offset:512
    ds_read_b64_tr_b16 v[76:77], v7 offset:32
    ds_read_b64_tr_b16 v[78:79], v7 offset:544
    ds_read_b64_tr_b16 v[80:81], v7 offset:64
    ds_read_b64_tr_b16 v[82:83], v7 offset:576
    ds_read_b64_tr_b16 v[84:85], v7 offset:96
    ds_read_b64_tr_b16 v[86:87], v7 offset:608
    s_waitcnt vmcnt(12)
    ds_read_b64_tr_b16 v[88:89], v7 offset:4096
    ds_read_b64_tr_b16 v[90:91], v7 offset:4608
    ds_read_b64_tr_b16 v[92:93], v7 offset:4128
    ds_read_b64_tr_b16 v[94:95], v7 offset:4640
    ds_read_b64_tr_b16 v[96:97], v7 offset:4160
    ds_read_b64_tr_b16 v[98:99], v7 offset:4672
    ds_read_b64_tr_b16 v[100:101], v7 offset:4192
    ds_read_b64_tr_b16 v[102:103], v7 offset:4704
    s_waitcnt lgkmcnt(8)
    v_mfma_f32_16x16x32_bf16 v[160:163], v[72:75], v[32:35], 0
    v_mfma_f32_16x16x32_bf16 v[164:167], v[76:79], v[32:35], 0
    v_mfma_f32_16x16x32_bf16 v[168:171], v[80:83], v[32:35], 0
    v_mfma_f32_16x16x32_bf16 v[172:175], v[84:87], v[32:35], 0
    s_waitcnt vmcnt(8)
    ds_read_b64_tr_b16 v[104:105], v7 offset:8192
    ds_read_b64_tr_b16 v[106:107], v7 offset:8704
    ds_read_b64_tr_b16 v[108:109], v7 offset:8224
    ds_read_b64_tr_b16 v[110:111], v7 offset:8736
    ds_read_b64_tr_b16 v[112:113], v7 offset:8256
    ds_read_b64_tr_b16 v[114:115], v7 offset:8768
    ds_read_b64_tr_b16 v[116:117], v7 offset:8288
    ds_read_b64_tr_b16 v[118:119], v7 offset:8800
    s_waitcnt lgkmcnt(8)
    v_mfma_f32_16x16x32_bf16 v[160:163], v[88:91], v[36:39], v[160:163]
    v_mfma_f32_16x16x32_bf16 v[164:167], v[92:95], v[36:39], v[164:167]
    v_mfma_f32_16x16x32_bf16 v[168:171], v[96:99], v[36:39], v[168:171]
    v_mfma_f32_16x16x32_bf16 v[172:175], v[100:103], v[36:39], v[172:175]
    s_waitcnt vmcnt(4)
    ds_read_b64_tr_b16 v[120:121], v7 offset:12288
    ds_read_b64_tr_b16 v[122:123], v7 offset:12800
    ds_read_b64_tr_b16 v[124:125], v7 offset:12320
    ds_read_b64_tr_b16 v[126:127], v7 offset:12832
    ds_read_b64_tr_b16 v[128:129], v7 offset:12352
    ds_read_b64_tr_b16 v[130:131], v7 offset:12864
    ds_read_b64_tr_b16 v[132:133], v7 offset:12384
    ds_read_b64_tr_b16 v[134:135], v7 offset:12896
    s_waitcnt lgkmcnt(8)
    v_mfma_f32_16x16x32_bf16 v[160:163], v[104:107], v[40:43], v[160:163]
    v_mfma_f32_16x16x32_bf16 v[164:167], v[108:111], v[40:43], v[164:167]
    v_mfma_f32_16x16x32_bf16 v[168:171], v[112:115], v[40:43], v[168:171]
    v_mfma_f32_16x16x32_bf16 v[172:175], v[116:119], v[40:43], v[172:175]
    s_waitcnt vmcnt(0)
    ds_read_b64_tr_b16 v[136:137], v7 offset:16384
    ds_read_b64_tr_b16 v[138:139], v7 offset:16896
    ds_read_b64_tr_b16 v[140:141], v7 offset:16416
    ds_read_b64_tr_b16 v[142:143], v7 offset:16928
    ds_read_b64_tr_b16 v[144:145], v7 offset:16448
    ds_read_b64_tr_b16 v[146:147], v7 offset:16960
    ds_read_b64_tr_b16 v[148:149], v7 offset:16480
    ds_read_b64_tr_b16 v[150:151], v7 offset:16992
    s_waitcnt lgkmcnt(8)
    v_mfma_f32_16x16x32_bf16 v[160:163], v[120:123], v[44:47], v[160:163]
    v_mfma_f32_16x16x32_bf16 v[164:167], v[124:127], v[44:47], v[164:167]
    v_mfma_f32_16x16x32_bf16 v[168:171], v[128:131], v[44:47], v[168:171]
    v_mfma_f32_16x16x32_bf16 v[172:175], v[132:135], v[44:47], v[172:175]
    s_waitcnt lgkmcnt(0)
    v_mfma_f32_16x16x32_bf16 v[160:163], v[136:139], v[48:51], v[160:163]
    v_mfma_f32_16x16x32_bf16 v[164:167], v[140:143], v[48:51], v[164:167]
    v_mfma_f32_16x16x32_bf16 v[168:171], v[144:147], v[48:51], v[168:171]
    v_mfma_f32_16x16x32_bf16 v[172:175], v[148:151], v[48:51], v[172:175]
    s_mov_b32 exec_lo, 0xf000f0
    s_mov_b32 exec_hi, 0xf000f0
    s_nop 3
    v_mov_b32 v160, v164
    v_mov_b32 v161, v165
    v_mov_b32 v162, v166
    v_mov_b32 v163, v167
    s_mov_b32 exec_lo, 0xf000f00
    s_mov_b32 exec_hi, 0xf000f00
    v_mov_b32 v160, v168
    v_mov_b32 v161, v169
    v_mov_b32 v162, v170
    v_mov_b32 v163, v171
    s_mov_b32 exec_lo, 0xf000f000
    s_mov_b32 exec_hi, 0xf000f000
    v_mov_b32 v160, v172
    v_mov_b32 v161, v173
    v_mov_b32 v162, v174
    v_mov_b32 v163, v175
    s_mov_b64 exec, -1
    v_add_u32 v160, 0x80, v160
    v_add_u32 v161, 0x80, v161
    v_add_u32 v162, 0x80, v162
    v_add_u32 v163, 0x80, v163
    v_perm_b32 v160, v160, v234, s64
    v_perm_b32 v161, v161, v234, s65
    v_perm_b32 v162, v162, v234, s66
    v_perm_b32 v163, v163, v234, s67
    buffer_store_dwordx4 v[160:163], v8, s[44:47], s56 offen sc1
    s_setprio 0
    s_branch L_w7m
L_w7n:
    s_barrier
    s_waitcnt lgkmcnt(0)
    s_add_u32 s4, s4, 1
L_w7m:
    s_mov_b32 s75, s6
    s_lshl_b32 s78, s75, 2
    s_add_u32 s78, s78, s73
    s_lshl_b32 s68, s75, 5
    s_add_u32 s68, s68, s5
    s_sub_u32 s68, s68, 160
    s_cmp_ge_u32 s75, 5
    s_cselect_b32 s78, s68, s78
    s_lshl_b32 s79, s5, 2
    s_cmp_eq_u32 s75, 0
    s_cselect_b32 s79, s79, -1
    s_cmp_eq_u32 s74, 4
    s_cselect_b32 s68, 36, -1
    s_cmp_eq_u32 s74, 2
    s_cselect_b32 s68, 32, s68
    s_cmp_eq_u32 s75, 2
    s_cselect_b32 s68, s68, -1
    s_add_u32 s69, s68, s73
    s_lshl_b32 s69, s69, 2
    s_cmp_lg_u32 s68, -1
    s_cselect_b32 s79, s69, s79
    s_add_u32 s77, s5, 20
    s_cmp_eq_u32 s75, 1
    s_cselect_b32 s77, s77, -1
    s_cmp_eq_u32 s74, 6
    s_cselect_b32 s68, 56, -1
    s_cmp_eq_u32 s74, 0
    s_cselect_b32 s68, 52, s68
    s_cmp_eq_u32 s75, 3
    s_cselect_b32 s68, s68, -1
    s_add_u32 s69, s68, s73
    s_cmp_lg_u32 s68, -1
    s_cselect_b32 s77, s69, s77
    s_sub_u32 s68, s75, 4
    s_lshl_b32 s76, s68, 5
    s_add_u32 s76, s76, s5
    s_cmp_lt_u32 s76, 80
    s_cselect_b32 s76, s76, -1
    s_lshl_b32 s68, s75, 2
    s_lshr_b32 s72, 0x44411155, s68
    s_and_b32 s72, s72, 15
    s_cmp_lg_u32 s77, -1
    s_cselect_b32 s72, 5, s72
    s_cmp_lg_u32 s79, -1
    s_cselect_b32 s72, 5, s72
L_prep:
    s_setprio 0
    s_sub_u32 s3, s3, 4
    v_and_b32 v2, 15, v1
    v_lshrrev_b32 v3, 4, v1
    v_and_b32 v15, 3, v1
L_lw_123:
    ds_read_b32 v13, v14 offset:24
    s_waitcnt lgkmcnt(0)
    v_readfirstlane_b32 s7, v13
    s_nop 0
    s_cmp_ge_u32 s7, 24
    s_cbranch_scc1 L_lwd_124
    s_sub_u32 s52, s52, 1
    s_cbranch_scc1 L_timeout
    s_sleep 16
    s_branch L_lw_123
L_lwd_124:
    v_mov_b32 v234, s4
    v_mov_b32 v249, 0
    s_mov_b32 s12, s38
    s_mov_b32 s13, s39
    s_mov_b32 s14, 5120
    s_mov_b32 s15, 0x20000
L_lw_125:
    ds_read_b32 v13, v14 offset:28
    s_waitcnt lgkmcnt(0)
    v_readfirstlane_b32 s7, v13
    s_nop 0
    s_cmp_lg_u32 s7, 0
    s_cbranch_scc1 L_lwd_126
    s_sub_u32 s52, s52, 1
    s_cbranch_scc1 L_timeout
    s_sleep 16
    s_branch L_lw_125
L_lwd_126:
    s_sub_u32 s41, s7, 1
    s_and_b32 s41, s41, 1
    s_and_b32 s27, s74, 3
    s_lshl_b32 s27, s27, 15
    s_lshr_b32 s7, s74, 2
    s_xor_b32 s7, s7, s41
    s_lshl_b32 s7, s7, 13
    s_add_u32 s27, s27, s7
    s_add_u32 s27, s27, 2621440
    s_cmp_ge_u32 s75, 5
    s_cbranch_scc1 L_gprep
    s_mul_i32 s51, s74, 10
    s_add_u32 s51, s51, s78
    s_cmp_ge_u32 s78, 12
    s_cselect_b32 s7, 10, 6
    s_sub_u32 s51, s51, s7
    s_lshr_b32 s7, 0xff0c0, s78
    s_bitcmp1_b32 s7, 0
    s_cselect_b32 s51, s51, -1
    s_cmp_eq_u32 s3, 3
    s_cselect_b32 s51, s51, -1
    s_cmp_eq_u32 s51, -1
    s_cbranch_scc1 L_nor
    s_mov_b32 s12, s16
    s_mov_b32 s13, s17
    s_mov_b32 s14, 5120
    s_mov_b32 s15, 0x20000
    v_and_b32 v11, 7, v1
    v_lshlrev_b32 v8, 4, v11
    v_mul_u32_u24 v9, 1280, v15
    v_lshl_add_u32 v9, v3, 1, v9
    v_and_b32 v11, 4, v1
    v_lshl_add_u32 v9, v11, 1, v9
    s_lshl_b32 s7, s51, 4
    buffer_load_ushort v154, v9, s[12:15], s7 offen
    s_lshl_b32 s56, s51, 7
    s_add_u32 s56, s56, 24576
    s_mov_b32 s60, 0xffffffff
    s_mov_b32 s61, 0xffffffff
L_gm_127:
    s_mov_b64 exec, s[60:61]
    buffer_load_dwordx3 v[176:178], v8, s[44:47], s56 offen offset:0 sc1
    s_waitcnt vmcnt(0)
    s_mov_b64 exec, s[60:61]
    v_cmp_ne_u32 s[60:61], s4, v178
    s_mov_b64 exec, -1
    s_or_b64 s[58:59], s[60:61], s[60:61]
    s_cbranch_scc0 L_gmd_128
    s_sub_u32 s52, s52, 1
    s_cbranch_scc1 L_timeout
    s_sleep 16
    s_branch L_gm_127
L_gmd_128:
    v_cmp_lt_u32 vcc, 31, v1
    s_nop 1
    v_cndmask_b32 v176, v176, v177, vcc
    v_lshlrev_b32 v154, 16, v154
    v_lshlrev_b32 v152, 16, v176
    v_and_b32 v177, s53, v176
    v_and_b32 v11, 1, v3
    v_cmp_ne_u32 vcc, 0, v11
    s_nop 1
    v_cndmask_b32 v152, v152, v177, vcc
L_nor:
    v_bfe_u32 v155, v1, 3, 2
    v_lshlrev_b32 v155, 15, v155
    v_lshrrev_b32 v11, 5, v1
    v_xor_b32 v11, s41, v11
    v_lshl_add_u32 v155, v11, 13, v155
    v_and_b32 v11, 7, v1
    v_lshl_add_u32 v155, v11, 4, v155
    v_and_b32 v4, 1, v2
    v_lshlrev_b32 v4, 3, v4
    v_lshrrev_b32 v5, 1, v2
    v_add_u32 v4, v4, v5
    v_lshlrev_b32 v4, 10, v4
    v_lshl_add_u32 v5, v3, 4, v4
    v_cmp_gt_u32 s[28:29], 2, v2
    v_lshlrev_b32 v6, 4, v2
    v_and_b32 v11, 1, v3
    v_lshl_add_u32 v6, v11, 6, v6
    v_lshrrev_b32 v11, 1, v3
    v_lshl_add_u32 v6, v11, 12, v6
    v_lshlrev_b32 v8, 4, v1
    v_mov_b32 v9, 0
    v_mov_b32 v10, 0
    s_cmp_eq_u32 s79, -1
    s_cbranch_scc1 L_nod
L_lw_129:
    ds_read_b32 v13, v14 offset:12
    s_waitcnt lgkmcnt(0)
    v_readfirstlane_b32 s7, v13
    s_nop 0
    s_cmp_ge_u32 s7, 2
    s_cbranch_scc1 L_lwd_130
    s_sub_u32 s52, s52, 1
    s_cbranch_scc1 L_timeout
    s_sleep 8
    s_branch L_lw_129
L_lwd_130:
    v_lshrrev_b32 v7, 2, v1
    v_lshlrev_b32 v7, 5, v7
    v_lshl_add_u32 v7, v15, 3, v7
    s_mul_i32 s7, s3, 12288
    s_add_u32 s7, s7, 79872
    v_add_u32 v243, s7, v7
    v_and_b32 v9, 12, v2
    v_add_u32 v9, v9, v3
    v_lshlrev_b32 v9, 6, v9
    v_lshl_add_u32 v9, v15, 4, v9
    v_lshlrev_b32 v7, 6, v3
    v_lshl_add_u32 v7, v15, 4, v7
    v_mul_u32_u24 v11, 1280, v15
    v_lshl_add_u32 v11, v3, 3, v11
    v_add_u32 v250, 142336, v7
    s_lshl_b32 s7, s3, 8
    v_add_u32 v251, s7, v250
    s_lshl_b32 s56, s79, 6
    s_add_u32 s56, s56, 55296
    s_mov_b32 s60, 0xffffffff
    s_mov_b32 s61, 0xffffffff
L_gm_131:
    s_mov_b64 exec, s[60:61]
    buffer_load_dwordx3 v[176:178], v7, s[44:47], s56 offen offset:0 sc1
    s_waitcnt vmcnt(0)
    s_mov_b64 exec, s[60:61]
    v_cmp_ne_u32 s[60:61], s4, v178
    s_mov_b64 exec, -1
    s_or_b64 s[58:59], s[60:61], s[60:61]
    s_cbranch_scc0 L_gmd_132
    s_sub_u32 s52, s52, 1
    s_cbranch_scc1 L_timeout
    s_sleep 16
    s_branch L_gm_131
L_gmd_132:
    v_lshlrev_b32 v156, 16, v176
    v_and_b32 v157, s53, v176
    v_lshlrev_b32 v158, 16, v177
    v_and_b32 v159, s53, v177
L_nod:
    v_lshrrev_b32 v242, 1, v1
    v_mul_u32_u24 v242, 1280, v242
    v_and_b32 v12, 1, v1
    v_lshl_add_u32 v242, v12, 4, v242
    s_mov_b32 s12, s38
    s_mov_b32 s13, s39
    s_mov_b32 s14, 5120
    s_mov_b32 s15, 0x20000
    v_lshrrev_b32 v253, 2, v2
    v_mul_u32_u24 v12, 6, v3
    v_add_u32 v253, v253, v12
    v_lshlrev_b32 v253, 8, v253
    v_lshl_add_u32 v253, v15, 3, v253
    s_lshl_b32 s7, s3, 6
    s_add_u32 s7, s7, 30720
    v_add_u32 v253, s7, v253
    s_cmp_eq_u32 s77, -1
    s_cbranch_scc1 L_nomod
L_lw_133:
    ds_read_b32 v13, v14 offset:16
    s_waitcnt lgkmcnt(0)
    v_readfirstlane_b32 s7, v13
    s_nop 0
    s_cmp_ge_u32 s7, 2
    s_cbranch_scc1 L_lwd_134
    s_sub_u32 s52, s52, 1
    s_cbranch_scc1 L_timeout
    s_sleep 8
    s_branch L_lw_133
L_lwd_134:
L_nomod:
L_rprep2:
    s_mul_i32 s7, s5, 245760
    s_lshl_b32 s56, s75, 8
    s_add_u32 s7, s7, s56
    s_add_u32 s8, s24, s7
    s_addc_u32 s9, s25, 0
    s_mov_b32 s10, 244736
    s_mov_b32 s11, 0x20000
    v_mul_u32_u24 v252, 1280, v3
    v_lshl_add_u32 v252, v2, 4, v252
    s_cmp_lg_u32 s3, 2
    s_cbranch_scc1 L_am_135
    v_lshrrev_b32 v216, 5, v1
    v_mul_u32_u24 v216, 768, v216
    v_and_b32 v217, 31, v1
    v_mul_u32_u24 v217, 24, v217
    v_add_u32 v216, v216, v217
    v_mov_b32 v217, 146176
    v_lshlrev_b32 v218, 4, v1
    s_lshl_b32 s58, s5, 5
    s_add_u32 s58, s58, s6
    s_lshl_b32 s58, s58, 10
    s_add_u32 s58, s58, 4194304
    s_and_b32 s59, s4, 0xbfffbfff
L_lw_136:
    ds_read_b32 v13, v14 offset:32
    s_waitcnt lgkmcnt(0)
    v_readfirstlane_b32 s7, v13
    s_nop 0
    s_cmp_ge_u32 s7, 4
    s_cbranch_scc1 L_lwd_137
    s_sub_u32 s52, s52, 1
    s_cbranch_scc1 L_timeout
    s_sleep 4
    s_branch L_lw_136
L_lwd_137:
    ds_read_b32 v12, v14 offset:0
    ds_read_b128 v[176:179], v217
    ds_read_b128 v[180:183], v217 offset:16
    ds_read_b64 v[184:185], v216 offset:0
    ds_read_b64 v[186:187], v216 offset:8
    ds_read_b64 v[188:189], v216 offset:16
    ds_read_b64 v[190:191], v216 offset:1536
    ds_read_b64 v[192:193], v216 offset:1544
    ds_read_b64 v[194:195], v216 offset:1552
    ds_read_b64 v[196:197], v216 offset:3072
    ds_read_b64 v[198:199], v216 offset:3080
    ds_read_b64 v[200:201], v216 offset:3088
    ds_read_b64 v[202:203], v216 offset:4608
    ds_read_b64 v[204:205], v216 offset:4616
    ds_read_b64 v[206:207], v216 offset:4624
    s_waitcnt lgkmcnt(14)
    v_readfirstlane_b32 s40, v12
    s_waitcnt lgkmcnt(12)
    v_max3_f32 v208, v176, v178, v180
    v_max_f32 v208, v208, v182
    v_sub_f32 v176, v176, v208
    v_sub_f32 v178, v178, v208
    v_sub_f32 v180, v180, v208
    v_sub_f32 v182, v182, v208
    v_exp_f32 v176, v176
    v_exp_f32 v178, v178
    v_exp_f32 v180, v180
    v_exp_f32 v182, v182
    v_mul_f32 v209, v176, v177
    v_fmac_f32 v209, v178, v179
    v_fmac_f32 v209, v180, v181
    v_fmac_f32 v209, v182, v183
    v_rcp_f32 v210, v209
    s_waitcnt lgkmcnt(0)
    v_pk_mul_f32 v[184:185], v[184:185], v[176:177] op_sel_hi:[1,0]
    v_pk_mul_f32 v[186:187], v[186:187], v[176:177] op_sel_hi:[1,0]
    v_pk_mul_f32 v[188:189], v[188:189], v[176:177] op_sel_hi:[1,0]
    v_pk_fma_f32 v[184:185], v[190:191], v[178:179], v[184:185] op_sel_hi:[1,0,1]
    v_pk_fma_f32 v[186:187], v[192:193], v[178:179], v[186:187] op_sel_hi:[1,0,1]
    v_pk_fma_f32 v[188:189], v[194:195], v[178:179], v[188:189] op_sel_hi:[1,0,1]
    v_pk_fma_f32 v[184:185], v[196:197], v[180:181], v[184:185] op_sel_hi:[1,0,1]
    v_pk_fma_f32 v[186:187], v[198:199], v[180:181], v[186:187] op_sel_hi:[1,0,1]
    v_pk_fma_f32 v[188:189], v[200:201], v[180:181], v[188:189] op_sel_hi:[1,0,1]
    v_pk_fma_f32 v[184:185], v[202:203], v[182:183], v[184:185] op_sel_hi:[1,0,1]
    v_pk_fma_f32 v[186:187], v[204:205], v[182:183], v[186:187] op_sel_hi:[1,0,1]
    v_pk_fma_f32 v[188:189], v[206:207], v[182:183], v[188:189] op_sel_hi:[1,0,1]
    v_permlane32_swap_b32 v184, v185
    v_permlane32_swap_b32 v186, v187
    v_permlane32_swap_b32 v188, v189
    v_add_f32 v184, v184, v185
    v_add_f32 v186, v186, v187
    v_add_f32 v188, v188, v189
    v_mul_f32 v184, v210, v184
    v_mul_f32 v186, v210, v186
    v_mul_f32 v188, v210, v188
    v_mov_b32 v185, v184
    v_mov_b32 v187, v186
    v_mov_b32 v189, v188
    v_permlane32_swap_b32 v184, v185
    v_permlane32_swap_b32 v186, v187
    v_permlane32_swap_b32 v188, v189
    v_cvt_pk_bf16_f32 v212, v184, v185
    v_cvt_pk_bf16_f32 v213, v186, v187
    v_cvt_pk_bf16_f32 v214, v188, v189
    v_mov_b32 v215, s59
    s_mov_b32 exec_lo, 0
    s_mov_b32 exec_hi, 1
    v_mov_b32 v212, v208
    v_mov_b32 v213, v209
    s_mov_b32 exec_lo, -1
    s_cmp_eq_u32 s40, 0
    s_cbranch_scc1 L_s2_138
    buffer_store_dwordx4 v[212:215], v218, s[44:47], s58 offen
    s_branch L_s2e_139
L_s2_138:
    s_nop 7
    buffer_store_dwordx4 v[212:215], v218, s[44:47], s58 offen sc1
L_s2e_139:
    s_mov_b64 exec, -1
L_am_135:
    s_cmp_lg_u32 s3, 2
    s_cbranch_scc1 L_am_140
    v_lshrrev_b32 v216, 5, v1
    v_mul_u32_u24 v216, 768, v216
    v_and_b32 v217, 31, v1
    v_mul_u32_u24 v217, 24, v217
    v_add_u32 v216, v216, v217
    v_mov_b32 v217, 146208
    v_lshlrev_b32 v218, 4, v1
    s_lshl_b32 s58, s5, 5
    s_add_u32 s58, s58, s6
    s_lshl_b32 s58, s58, 10
    s_add_u32 s58, s58, 4202496
    s_and_b32 s59, s4, 0xbfffbfff
L_lw_141:
    ds_read_b32 v13, v14 offset:36
    s_waitcnt lgkmcnt(0)
    v_readfirstlane_b32 s7, v13
    s_nop 0
    s_cmp_ge_u32 s7, 4
    s_cbranch_scc1 L_lwd_142
    s_sub_u32 s52, s52, 1
    s_cbranch_scc1 L_timeout
    s_sleep 4
    s_branch L_lw_141
L_lwd_142:
    ds_read_b32 v12, v14 offset:0
    ds_read_b128 v[176:179], v217
    ds_read_b128 v[180:183], v217 offset:16
    ds_read_b64 v[184:185], v216 offset:6144
    ds_read_b64 v[186:187], v216 offset:6152
    ds_read_b64 v[188:189], v216 offset:6160
    ds_read_b64 v[190:191], v216 offset:7680
    ds_read_b64 v[192:193], v216 offset:7688
    ds_read_b64 v[194:195], v216 offset:7696
    ds_read_b64 v[196:197], v216 offset:9216
    ds_read_b64 v[198:199], v216 offset:9224
    ds_read_b64 v[200:201], v216 offset:9232
    ds_read_b64 v[202:203], v216 offset:10752
    ds_read_b64 v[204:205], v216 offset:10760
    ds_read_b64 v[206:207], v216 offset:10768
    s_waitcnt lgkmcnt(14)
    v_readfirstlane_b32 s40, v12
    s_waitcnt lgkmcnt(12)
    v_max3_f32 v208, v176, v178, v180
    v_max_f32 v208, v208, v182
    v_sub_f32 v176, v176, v208
    v_sub_f32 v178, v178, v208
    v_sub_f32 v180, v180, v208
    v_sub_f32 v182, v182, v208
    v_exp_f32 v176, v176
    v_exp_f32 v178, v178
    v_exp_f32 v180, v180
    v_exp_f32 v182, v182
    v_mul_f32 v209, v176, v177
    v_fmac_f32 v209, v178, v179
    v_fmac_f32 v209, v180, v181
    v_fmac_f32 v209, v182, v183
    v_rcp_f32 v210, v209
    s_waitcnt lgkmcnt(0)
    v_pk_mul_f32 v[184:185], v[184:185], v[176:177] op_sel_hi:[1,0]
    v_pk_mul_f32 v[186:187], v[186:187], v[176:177] op_sel_hi:[1,0]
    v_pk_mul_f32 v[188:189], v[188:189], v[176:177] op_sel_hi:[1,0]
    v_pk_fma_f32 v[184:185], v[190:191], v[178:179], v[184:185] op_sel_hi:[1,0,1]
    v_pk_fma_f32 v[186:187], v[192:193], v[178:179], v[186:187] op_sel_hi:[1,0,1]
    v_pk_fma_f32 v[188:189], v[194:195], v[178:179], v[188:189] op_sel_hi:[1,0,1]
    v_pk_fma_f32 v[184:185], v[196:197], v[180:181], v[184:185] op_sel_hi:[1,0,1]
    v_pk_fma_f32 v[186:187], v[198:199], v[180:181], v[186:187] op_sel_hi:[1,0,1]
    v_pk_fma_f32 v[188:189], v[200:201], v[180:181], v[188:189] op_sel_hi:[1,0,1]
    v_pk_fma_f32 v[184:185], v[202:203], v[182:183], v[184:185] op_sel_hi:[1,0,1]
    v_pk_fma_f32 v[186:187], v[204:205], v[182:183], v[186:187] op_sel_hi:[1,0,1]
    v_pk_fma_f32 v[188:189], v[206:207], v[182:183], v[188:189] op_sel_hi:[1,0,1]
    v_permlane32_swap_b32 v184, v185
    v_permlane32_swap_b32 v186, v187
    v_permlane32_swap_b32 v188, v189
    v_add_f32 v184, v184, v185
    v_add_f32 v186, v186, v187
    v_add_f32 v188, v188, v189
    v_mul_f32 v184, v210, v184
    v_mul_f32 v186, v210, v186
    v_mul_f32 v188, v210, v188
    v_mov_b32 v185, v184
    v_mov_b32 v187, v186
    v_mov_b32 v189, v188
    v_permlane32_swap_b32 v184, v185
    v_permlane32_swap_b32 v186, v187
    v_permlane32_swap_b32 v188, v189
    v_cvt_pk_bf16_f32 v212, v184, v185
    v_cvt_pk_bf16_f32 v213, v186, v187
    v_cvt_pk_bf16_f32 v214, v188, v189
    v_mov_b32 v215, s59
    s_mov_b32 exec_lo, 0
    s_mov_b32 exec_hi, 1
    v_mov_b32 v212, v208
    v_mov_b32 v213, v209
    s_mov_b32 exec_lo, -1
    s_cmp_eq_u32 s40, 0
    s_cbranch_scc1 L_s2_143
    buffer_store_dwordx4 v[212:215], v218, s[44:47], s58 offen
    s_branch L_s2e_144
L_s2_143:
    s_nop 7
    buffer_store_dwordx4 v[212:215], v218, s[44:47], s58 offen sc1
L_s2e_144:
    s_mov_b64 exec, -1
L_am_140:
L_lw_145:
    ds_read_b32 v13, v14 offset:36
    s_waitcnt lgkmcnt(0)
    v_readfirstlane_b32 s7, v13
    s_nop 0
    s_cmp_ge_u32 s7, 4
    s_cbranch_scc1 L_lwd_146
    s_sub_u32 s52, s52, 1
    s_cbranch_scc1 L_timeout
    s_sleep 4
    s_branch L_lw_145
L_lwd_146:
    s_lshl_b32 s56, s5, 15
    s_add_u32 s56, s56, 4194304
    s_lshl_b32 s7, s3, 7
    s_add_u32 s69, s56, s7
    s_and_b32 s60, s4, 0xbfffbfff
L_gf_147:
    buffer_load_dwordx4 v[208:211], v4, s[44:47], s56 offen offset:512 sc1
    buffer_load_dwordx4 v[176:179], v5, s[44:47], s69 offen offset:0 sc1
    buffer_load_dwordx4 v[180:183], v5, s[44:47], s69 offen offset:64 sc1
    s_waitcnt vmcnt(1)
    v_min_u32 v12, v211, v179
    v_max_u32 v13, v211, v179
    s_waitcnt vmcnt(0)
    v_min_u32 v12, v12, v183
    v_max_u32 v13, v13, v183
    v_cmp_ne_u32 s[58:59], s60, v12
    v_cmp_ne_u32 vcc, s60, v13
    s_nop 0
    s_or_b64 exec, s[58:59], vcc
    s_cbranch_scc0 L_gfd_148
    s_sub_u32 s52, s52, 1
    s_cbranch_scc1 L_timeout
    s_sleep 4
    s_branch L_gf_147
L_gfd_148:
    s_mov_b64 exec, -1
    s_mul_i32 s56, s3, 12288
    s_add_u32 s56, s56, 30720
    s_mov_b32 m0, s56
    s_mul_i32 s57, s3, 61440
    buffer_load_dwordx4 v252, s[8:11], s57 offen nt lds
    s_add_u32 m0, m0, 1024
    s_add_u32 s57, s57, 5120
    buffer_load_dwordx4 v252, s[8:11], s57 offen nt lds
    s_add_u32 m0, m0, 1024
    s_add_u32 s57, s57, 5120
    buffer_load_dwordx4 v252, s[8:11], s57 offen nt lds
    s_add_u32 m0, m0, 1024
    s_add_u32 s57, s57, 5120
    buffer_load_dwordx4 v252, s[8:11], s57 offen nt lds
    s_add_u32 m0, m0, 1024
    s_add_u32 s57, s57, 5120
    buffer_load_dwordx4 v252, s[8:11], s57 offen nt lds
    s_add_u32 m0, m0, 1024
    s_add_u32 s57, s57, 5120
    buffer_load_dwordx4 v252, s[8:11], s57 offen nt lds
    s_add_u32 m0, m0, 1024
    s_add_u32 s57, s57, 5120
    s_waitcnt vmcnt(5)
    buffer_load_dwordx4 v252, s[8:11], s57 offen nt lds
    s_add_u32 m0, m0, 1024
    s_add_u32 s57, s57, 5120
    s_waitcnt vmcnt(5)
    buffer_load_dwordx4 v252, s[8:11], s57 offen nt lds
    s_add_u32 m0, m0, 1024
    s_add_u32 s57, s57, 5120
    s_waitcnt vmcnt(5)
    buffer_load_dwordx4 v252, s[8:11], s57 offen nt lds
    s_add_u32 m0, m0, 1024
    s_add_u32 s57, s57, 5120
    s_waitcnt vmcnt(5)
    buffer_load_dwordx4 v252, s[8:11], s57 offen nt lds
    s_add_u32 m0, m0, 1024
    s_add_u32 s57, s57, 5120
    s_waitcnt vmcnt(5)
    buffer_load_dwordx4 v252, s[8:11], s57 offen nt lds
    s_add_u32 m0, m0, 1024
    s_add_u32 s57, s57, 5120
    s_waitcnt vmcnt(5)
    buffer_load_dwordx4 v252, s[8:11], s57 offen nt lds
    s_waitcnt vmcnt(0)
    s_mov_b64 exec, 1
    v_mov_b32 v13, 1
    ds_add_u32 v14, v13 offset:8
    s_mov_b64 exec, -1
L_lw_149:
    ds_read_b32 v13, v14 offset:8
    s_waitcnt lgkmcnt(0)
    v_readfirstlane_b32 s7, v13
    s_nop 0
    s_cmp_ge_u32 s7, 4
    s_cbranch_scc1 L_lwd_150
    s_sub_u32 s52, s52, 1
    s_cbranch_scc1 L_timeout
    s_branch L_lw_149
L_lwd_150:
    ds_read_b64_tr_b16 v[16:17], v253 offset:0
    ds_read_b64_tr_b16 v[18:19], v253 offset:1024
    ds_read_b64_tr_b16 v[20:21], v253 offset:6144
    ds_read_b64_tr_b16 v[22:23], v253 offset:7168
    ds_read_b64_tr_b16 v[24:25], v253 offset:12288
    ds_read_b64_tr_b16 v[26:27], v253 offset:13312
    ds_read_b64_tr_b16 v[28:29], v253 offset:18432
    ds_read_b64_tr_b16 v[30:31], v253 offset:19456
    ds_read_b64_tr_b16 v[32:33], v253 offset:24576
    ds_read_b64_tr_b16 v[34:35], v253 offset:25600
    ds_read_b64_tr_b16 v[36:37], v253 offset:30720
    ds_read_b64_tr_b16 v[38:39], v253 offset:31744
    ds_read_b64_tr_b16 v[40:41], v253 offset:36864
    ds_read_b64_tr_b16 v[42:43], v253 offset:37888
    ds_read_b64_tr_b16 v[44:45], v253 offset:43008
    ds_read_b64_tr_b16 v[46:47], v253 offset:44032
    ds_read_b64_tr_b16 v[48:49], v253 offset:32
    ds_read_b64_tr_b16 v[50:51], v253 offset:1056
    ds_read_b64_tr_b16 v[52:53], v253 offset:6176
    ds_read_b64_tr_b16 v[54:55], v253 offset:7200
    ds_read_b64_tr_b16 v[56:57], v253 offset:12320
    ds_read_b64_tr_b16 v[58:59], v253 offset:13344
    ds_read_b64_tr_b16 v[60:61], v253 offset:18464
    ds_read_b64_tr_b16 v[62:63], v253 offset:19488
    ds_read_b64_tr_b16 v[64:65], v253 offset:24608
    ds_read_b64_tr_b16 v[66:67], v253 offset:25632
    ds_read_b64_tr_b16 v[68:69], v253 offset:30752
    ds_read_b64_tr_b16 v[70:71], v253 offset:31776
    ds_read_b64_tr_b16 v[72:73], v253 offset:36896
    ds_read_b64_tr_b16 v[74:75], v253 offset:37920
    ds_read_b64_tr_b16 v[76:77], v253 offset:43040
    ds_read_b64_tr_b16 v[78:79], v253 offset:44064
    s_waitcnt lgkmcnt(0)
    v_mov_b32 v19, 0
    v_mov_b32 v23, 0
    v_mov_b32 v27, 0
    v_mov_b32 v31, 0
    v_mov_b32 v35, 0
    v_mov_b32 v39, 0
    v_mov_b32 v43, 0
    v_mov_b32 v47, 0
    v_mov_b32 v51, 0
    v_mov_b32 v55, 0
    v_mov_b32 v59, 0
    v_mov_b32 v63, 0
    v_mov_b32 v67, 0
    v_mov_b32 v71, 0
    v_mov_b32 v75, 0
    v_mov_b32 v79, 0
L_tail:
    s_lshl_b32 s56, s5, 15
    s_add_u32 s56, s56, 4194304
    s_lshl_b32 s57, s75, 2
    s_add_u32 s57, s57, s3
    s_lshl_b32 s57, s57, 2
    s_add_u32 s50, s57, 2
    s_cmp_ge_u32 s57, 40
    s_cselect_b32 s58, 40, 0
    s_cselect_b32 s59, 1, 0
    s_sub_u32 s58, s57, s58
    s_xor_b32 s59, s59, s41
    s_lshl_b32 s59, s59, 13
    s_and_b32 s7, s58, 1
    s_lshl_b32 s7, s7, 12
    s_add_u32 s59, s59, s7
    s_lshr_b32 s58, s58, 1
    s_lshl_b32 s58, s58, 14
    s_add_u32 s57, s58, s59
    s_add_u32 s57, s57, 2097152
    s_cmp_ge_u32 s50, 40
    s_cselect_b32 s58, 40, 0
    s_cselect_b32 s59, 1, 0
    s_sub_u32 s58, s50, s58
    s_xor_b32 s59, s59, s41
    s_lshl_b32 s59, s59, 13
    s_and_b32 s7, s58, 1
    s_lshl_b32 s7, s7, 12
    s_add_u32 s59, s59, s7
    s_lshr_b32 s58, s58, 1
    s_lshl_b32 s58, s58, 14
    s_add_u32 s50, s58, s59
    s_add_u32 s50, s50, 2097152
    s_lshl_b32 s7, s5, 7
    s_add_u32 s57, s57, s7
    s_add_u32 s50, s50, s7
    s_cmp_ge_u32 s51, 40
    s_cselect_b32 s58, 40, 0
    s_cselect_b32 s59, 1, 0
    s_sub_u32 s58, s51, s58
    s_xor_b32 s59, s59, s41
    s_lshl_b32 s59, s59, 13
    s_and_b32 s7, s58, 1
    s_lshl_b32 s7, s7, 12
    s_add_u32 s59, s59, s7
    s_lshr_b32 s58, s58, 1
    s_lshl_b32 s58, s58, 14
    s_add_u32 s48, s58, s59
    s_add_u32 s48, s48, 2097152
    s_lshl_b32 s49, s51, 7
    s_and_b32 s7, s49, 0x2000
    s_add_u32 s49, s49, s7
    s_add_u32 s49, s49, 2621440
    s_mov_b32 s61, 0xffffff00
    s_mov_b32 s62, 0x0c0c0400
    s_mov_b32 s63, 0x04000c0c
    s_mov_b32 s64, 0x07060500
    s_mov_b32 s65, 0x07060501
    s_mov_b32 s66, 0x07060502
    s_mov_b32 s67, 0x07060503
    s_and_b32 s60, s4, 0xbfffbfff
    v_lshlrev_b32 v246, 4, v1
    v_add_u32 v246, 134144, v246
    s_lshl_b32 s7, s3, 11
    v_add_u32 v247, s7, v246
    ds_write_b128 v247, v[176:179]
    ds_write_b128 v247, v[180:183] offset:1024
    s_mov_b64 exec, 1
    v_mov_b32 v13, 1
    ds_add_u32 v14, v13 offset:8
    s_mov_b64 exec, -1
L_lw_151:
    ds_read_b32 v13, v14 offset:8
    s_waitcnt lgkmcnt(0)
    v_readfirstlane_b32 s7, v13
    s_nop 0
    s_cmp_ge_u32 s7, 8
    s_cbranch_scc1 L_lwd_152
    s_sub_u32 s52, s52, 1
    s_cbranch_scc1 L_timeout
    s_branch L_lw_151
L_lwd_152:
    ds_read_b128 v[176:179], v246 offset:0
    ds_read_b128 v[180:183], v246 offset:1024
    ds_read_b128 v[184:187], v246 offset:2048
    ds_read_b128 v[188:191], v246 offset:3072
    ds_read_b128 v[192:195], v246 offset:4096
    ds_read_b128 v[196:199], v246 offset:5120
    ds_read_b128 v[200:203], v246 offset:6144
    ds_read_b128 v[204:207], v246 offset:7168
    s_waitcnt lgkmcnt(0)
    s_mov_b64 exec, 1
    v_mov_b32 v13, 1
    ds_add_u32 v14, v13 offset:8
    s_mov_b64 exec, -1
    v_mfma_f32_16x16x32_bf16 v[128:131], v[16:19], v[176:179], 0
    v_max_f32_dpp v212, v208, v208 row_ror:2 row_mask:0xf bank_mask:0xf
    s_nop 0
    v_mfma_f32_16x16x32_bf16 v[132:135], v[48:51], v[176:179], 0
    v_max_f32_dpp v212, v212, v212 row_ror:4 row_mask:0xf bank_mask:0xf
    s_nop 0
    v_mfma_f32_16x16x32_bf16 v[128:131], v[20:23], v[180:183], v[128:131]
    v_max_f32_dpp v212, v212, v212 row_ror:8 row_mask:0xf bank_mask:0xf
    s_nop 0
    v_mfma_f32_16x16x32_bf16 v[132:135], v[52:55], v[180:183], v[132:135]
    v_sub_f32 v212, v208, v212
    v_exp_f32 v212, v212
    s_nop 0
    v_mfma_f32_16x16x32_bf16 v[128:131], v[24:27], v[184:187], v[128:131]
    v_mul_f32 v212, v212, v209
    s_nop 0
    v_mfma_f32_16x16x32_bf16 v[132:135], v[56:59], v[184:187], v[132:135]
    v_add_f32_dpp v213, v212, v212 row_ror:2 row_mask:0xf bank_mask:0xf
    s_nop 0
    v_mfma_f32_16x16x32_bf16 v[128:131], v[28:31], v[188:191], v[128:131]
    v_add_f32_dpp v213, v213, v213 row_ror:4 row_mask:0xf bank_mask:0xf
    s_nop 0
    v_mfma_f32_16x16x32_bf16 v[132:135], v[60:63], v[188:191], v[132:135]
    v_add_f32_dpp v213, v213, v213 row_ror:8 row_mask:0xf bank_mask:0xf
    s_nop 0
    v_mfma_f32_16x16x32_bf16 v[128:131], v[32:35], v[192:195], v[128:131]
    v_rcp_f32 v213, v213
    s_nop 0
    v_mfma_f32_16x16x32_bf16 v[132:135], v[64:67], v[192:195], v[132:135]
    v_mul_f32 v212, v212, v213
    s_nop 0
    v_mfma_f32_16x16x32_bf16 v[128:131], v[36:39], v[196:199], v[128:131]
    v_mfma_f32_16x16x32_bf16 v[132:135], v[68:71], v[196:199], v[132:135]
    v_mfma_f32_16x16x32_bf16 v[128:131], v[40:43], v[200:203], v[128:131]
    v_mfma_f32_16x16x32_bf16 v[132:135], v[72:75], v[200:203], v[132:135]
    v_mfma_f32_16x16x32_bf16 v[128:131], v[44:47], v[204:207], v[128:131]
    v_mfma_f32_16x16x32_bf16 v[132:135], v[76:79], v[204:207], v[132:135]
    s_nop 6
    v_pk_mul_f32 v[128:129], v[128:129], v[212:213] op_sel_hi:[1,0]
    v_pk_mul_f32 v[130:131], v[130:131], v[212:213] op_sel_hi:[1,0]
    v_pk_mul_f32 v[132:133], v[132:133], v[212:213] op_sel_hi:[1,0]
    v_pk_mul_f32 v[134:135], v[134:135], v[212:213] op_sel_hi:[1,0]
    v_add_f32_dpp v128, v128, v128 row_ror:2 row_mask:0xf bank_mask:0xf
    v_add_f32_dpp v129, v129, v129 row_ror:2 row_mask:0xf bank_mask:0xf
    v_add_f32_dpp v130, v130, v130 row_ror:2 row_mask:0xf bank_mask:0xf
    v_add_f32_dpp v131, v131, v131 row_ror:2 row_mask:0xf bank_mask:0xf
    v_add_f32_dpp v132, v132, v132 row_ror:2 row_mask:0xf bank_mask:0xf
    v_add_f32_dpp v133, v133, v133 row_ror:2 row_mask:0xf bank_mask:0xf
    v_add_f32_dpp v134, v134, v134 row_ror:2 row_mask:0xf bank_mask:0xf
    v_add_f32_dpp v135, v135, v135 row_ror:2 row_mask:0xf bank_mask:0xf
    v_add_f32_dpp v128, v128, v128 row_ror:4 row_mask:0xf bank_mask:0xf
    v_add_f32_dpp v129, v129, v129 row_ror:4 row_mask:0xf bank_mask:0xf
    v_add_f32_dpp v130, v130, v130 row_ror:4 row_mask:0xf bank_mask:0xf
    v_add_f32_dpp v131, v131, v131 row_ror:4 row_mask:0xf bank_mask:0xf
    v_add_f32_dpp v132, v132, v132 row_ror:4 row_mask:0xf bank_mask:0xf
    v_add_f32_dpp v133, v133, v133 row_ror:4 row_mask:0xf bank_mask:0xf
    v_add_f32_dpp v134, v134, v134 row_ror:4 row_mask:0xf bank_mask:0xf
    v_add_f32_dpp v135, v135, v135 row_ror:4 row_mask:0xf bank_mask:0xf
    v_add_f32_dpp v128, v128, v128 row_ror:8 row_mask:0xf bank_mask:0xf
    v_add_f32_dpp v129, v129, v129 row_ror:8 row_mask:0xf bank_mask:0xf
    v_add_f32_dpp v130, v130, v130 row_ror:8 row_mask:0xf bank_mask:0xf
    v_add_f32_dpp v131, v131, v131 row_ror:8 row_mask:0xf bank_mask:0xf
    v_add_f32_dpp v132, v132, v132 row_ror:8 row_mask:0xf bank_mask:0xf
    v_add_f32_dpp v133, v133, v133 row_ror:8 row_mask:0xf bank_mask:0xf
    v_add_f32_dpp v134, v134, v134 row_ror:8 row_mask:0xf bank_mask:0xf
    v_add_f32_dpp v135, v135, v135 row_ror:8 row_mask:0xf bank_mask:0xf
    s_add_u32 s56, s56, 16384
    s_cmp_lg_u32 s3, 2
    s_cbranch_scc1 L_am_153
    v_lshrrev_b32 v216, 5, v1
    v_mul_u32_u24 v216, 768, v216
    v_and_b32 v217, 31, v1
    v_mul_u32_u24 v217, 24, v217
    v_add_u32 v216, v216, v217
    v_mov_b32 v217, 146240
    v_lshlrev_b32 v218, 4, v1
    s_lshl_b32 s58, s5, 5
    s_add_u32 s58, s58, s6
    s_lshl_b32 s58, s58, 10
    s_add_u32 s58, s58, 4210688
    s_and_b32 s59, s4, 0xbfffbfff
L_lw_154:
    ds_read_b32 v13, v14 offset:40
    s_waitcnt lgkmcnt(0)
    v_readfirstlane_b32 s7, v13
    s_nop 0
    s_cmp_ge_u32 s7, 4
    s_cbranch_scc1 L_lwd_155
    s_sub_u32 s52, s52, 1
    s_cbranch_scc1 L_timeout
    s_sleep 1
    s_branch L_lw_154
L_lwd_155:
    ds_read_b32 v12, v14 offset:0
    ds_read_b128 v[176:179], v217
    ds_read_b128 v[180:183], v217 offset:16
    ds_read_b64 v[184:185], v216 offset:12288
    ds_read_b64 v[186:187], v216 offset:12296
    ds_read_b64 v[188:189], v216 offset:12304
    ds_read_b64 v[190:191], v216 offset:13824
    ds_read_b64 v[192:193], v216 offset:13832
    ds_read_b64 v[194:195], v216 offset:13840
    ds_read_b64 v[196:197], v216 offset:15360
    ds_read_b64 v[198:199], v216 offset:15368
    ds_read_b64 v[200:201], v216 offset:15376
    ds_read_b64 v[202:203], v216 offset:16896
    ds_read_b64 v[204:205], v216 offset:16904
    ds_read_b64 v[206:207], v216 offset:16912
    s_waitcnt lgkmcnt(14)
    v_readfirstlane_b32 s40, v12
    s_waitcnt lgkmcnt(12)
    v_max3_f32 v208, v176, v178, v180
    v_max_f32 v208, v208, v182
    v_sub_f32 v176, v176, v208
    v_sub_f32 v178, v178, v208
    v_sub_f32 v180, v180, v208
    v_sub_f32 v182, v182, v208
    v_exp_f32 v176, v176
    v_exp_f32 v178, v178
    v_exp_f32 v180, v180
    v_exp_f32 v182, v182
    v_mul_f32 v209, v176, v177
    v_fmac_f32 v209, v178, v179
    v_fmac_f32 v209, v180, v181
    v_fmac_f32 v209, v182, v183
    v_rcp_f32 v210, v209
    s_waitcnt lgkmcnt(0)
    v_pk_mul_f32 v[184:185], v[184:185], v[176:177] op_sel_hi:[1,0]
    v_pk_mul_f32 v[186:187], v[186:187], v[176:177] op_sel_hi:[1,0]
    v_pk_mul_f32 v[188:189], v[188:189], v[176:177] op_sel_hi:[1,0]
    v_pk_fma_f32 v[184:185], v[190:191], v[178:179], v[184:185] op_sel_hi:[1,0,1]
    v_pk_fma_f32 v[186:187], v[192:193], v[178:179], v[186:187] op_sel_hi:[1,0,1]
    v_pk_fma_f32 v[188:189], v[194:195], v[178:179], v[188:189] op_sel_hi:[1,0,1]
    v_pk_fma_f32 v[184:185], v[196:197], v[180:181], v[184:185] op_sel_hi:[1,0,1]
    v_pk_fma_f32 v[186:187], v[198:199], v[180:181], v[186:187] op_sel_hi:[1,0,1]
    v_pk_fma_f32 v[188:189], v[200:201], v[180:181], v[188:189] op_sel_hi:[1,0,1]
    v_pk_fma_f32 v[184:185], v[202:203], v[182:183], v[184:185] op_sel_hi:[1,0,1]
    v_pk_fma_f32 v[186:187], v[204:205], v[182:183], v[186:187] op_sel_hi:[1,0,1]
    v_pk_fma_f32 v[188:189], v[206:207], v[182:183], v[188:189] op_sel_hi:[1,0,1]
    v_permlane32_swap_b32 v184, v185
    v_permlane32_swap_b32 v186, v187
    v_permlane32_swap_b32 v188, v189
    v_add_f32 v184, v184, v185
    v_add_f32 v186, v186, v187
    v_add_f32 v188, v188, v189
    v_mul_f32 v184, v210, v184
    v_mul_f32 v186, v210, v186
    v_mul_f32 v188, v210, v188
    v_mov_b32 v185, v184
    v_mov_b32 v187, v186
    v_mov_b32 v189, v188
    v_permlane32_swap_b32 v184, v185
    v_permlane32_swap_b32 v186, v187
    v_permlane32_swap_b32 v188, v189
    v_cvt_pk_bf16_f32 v212, v184, v185
    v_cvt_pk_bf16_f32 v213, v186, v187
    v_cvt_pk_bf16_f32 v214, v188, v189
    v_mov_b32 v215, s59
    s_mov_b32 exec_lo, 0
    s_mov_b32 exec_hi, 1
    v_mov_b32 v212, v208
    v_mov_b32 v213, v209
    s_mov_b32 exec_lo, -1
    s_cmp_eq_u32 s40, 0
    s_cbranch_scc1 L_s2_156
    buffer_store_dwordx4 v[212:215], v218, s[44:47], s58 offen
    s_branch L_s2e_157
L_s2_156:
    s_nop 7
    buffer_store_dwordx4 v[212:215], v218, s[44:47], s58 offen sc1
L_s2e_157:
    s_mov_b64 exec, -1
L_am_153:
L_lw_158:
    ds_read_b32 v13, v14 offset:8
    s_waitcnt lgkmcnt(0)
    v_readfirstlane_b32 s7, v13
    s_nop 0
    s_cmp_ge_u32 s7, 12
    s_cbranch_scc1 L_lwd_159
    s_sub_u32 s52, s52, 1
    s_cbranch_scc1 L_timeout
    s_sleep 1
    s_branch L_lw_158
L_lwd_159:
L_lw_160:
    ds_read_b32 v13, v14 offset:40
    s_waitcnt lgkmcnt(0)
    v_readfirstlane_b32 s7, v13
    s_nop 0
    s_cmp_ge_u32 s7, 4
    s_cbranch_scc1 L_lwd_161
    s_sub_u32 s52, s52, 1
    s_cbranch_scc1 L_timeout
    s_sleep 2
    s_branch L_lw_160
L_lwd_161:
    s_lshl_b32 s7, s3, 7
    s_add_u32 s58, s56, s7
    s_mov_b32 s69, s58
L_gf_162:
    buffer_load_dwordx4 v[208:211], v4, s[44:47], s56 offen offset:512 sc1
    buffer_load_dwordx4 v[176:179], v5, s[44:47], s69 offen offset:0 sc1
    buffer_load_dwordx4 v[180:183], v5, s[44:47], s69 offen offset:64 sc1
    s_waitcnt vmcnt(1)
    v_min_u32 v12, v211, v179
    v_max_u32 v13, v211, v179
    s_waitcnt vmcnt(0)
    v_min_u32 v12, v12, v183
    v_max_u32 v13, v13, v183
    v_cmp_ne_u32 s[58:59], s60, v12
    v_cmp_ne_u32 vcc, s60, v13
    s_nop 0
    s_or_b64 exec, s[58:59], vcc
    s_cbranch_scc0 L_gfd_163
    s_sub_u32 s52, s52, 1
    s_cbranch_scc1 L_timeout
    s_branch L_gf_162
L_gfd_163:
    s_mov_b64 exec, -1
    ds_write_b128 v247, v[176:179]
    ds_write_b128 v247, v[180:183] offset:1024
    s_waitcnt lgkmcnt(0)
    s_barrier
    ds_read_b128 v[176:179], v246 offset:0
    ds_read_b128 v[180:183], v246 offset:1024
    ds_read_b128 v[184:187], v246 offset:2048
    ds_read_b128 v[188:191], v246 offset:3072
    ds_read_b128 v[192:195], v246 offset:4096
    ds_read_b128 v[196:199], v246 offset:5120
    ds_read_b128 v[200:203], v246 offset:6144
    ds_read_b128 v[204:207], v246 offset:7168
    s_waitcnt lgkmcnt(0)
    v_mfma_f32_16x16x32_bf16 v[224:227], v[16:19], v[176:179], 0
    v_max_f32_dpp v212, v208, v208 row_ror:2 row_mask:0xf bank_mask:0xf
    s_nop 0
    v_mfma_f32_16x16x32_bf16 v[228:231], v[48:51], v[176:179], 0
    v_max_f32_dpp v212, v212, v212 row_ror:4 row_mask:0xf bank_mask:0xf
    s_nop 0
    v_mfma_f32_16x16x32_bf16 v[224:227], v[20:23], v[180:183], v[224:227]
    v_max_f32_dpp v212, v212, v212 row_ror:8 row_mask:0xf bank_mask:0xf
    s_nop 0
    v_mfma_f32_16x16x32_bf16 v[228:231], v[52:55], v[180:183], v[228:231]
    v_sub_f32 v212, v208, v212
    v_exp_f32 v212, v212
    s_nop 0
    v_mfma_f32_16x16x32_bf16 v[224:227], v[24:27], v[184:187], v[224:227]
    v_mul_f32 v212, v212, v209
    s_nop 0
    v_mfma_f32_16x16x32_bf16 v[228:231], v[56:59], v[184:187], v[228:231]
    v_add_f32_dpp v213, v212, v212 row_ror:2 row_mask:0xf bank_mask:0xf
    s_nop 0
    v_mfma_f32_16x16x32_bf16 v[224:227], v[28:31], v[188:191], v[224:227]
    v_add_f32_dpp v213, v213, v213 row_ror:4 row_mask:0xf bank_mask:0xf
    s_nop 0
    v_mfma_f32_16x16x32_bf16 v[228:231], v[60:63], v[188:191], v[228:231]
    v_add_f32_dpp v213, v213, v213 row_ror:8 row_mask:0xf bank_mask:0xf
    s_nop 0
    v_mfma_f32_16x16x32_bf16 v[224:227], v[32:35], v[192:195], v[224:227]
    v_rcp_f32 v213, v213
    s_nop 0
    v_mfma_f32_16x16x32_bf16 v[228:231], v[64:67], v[192:195], v[228:231]
    v_mul_f32 v212, v212, v213
    s_nop 0
    v_mfma_f32_16x16x32_bf16 v[224:227], v[36:39], v[196:199], v[224:227]
    v_mfma_f32_16x16x32_bf16 v[228:231], v[68:71], v[196:199], v[228:231]
    v_mfma_f32_16x16x32_bf16 v[224:227], v[40:43], v[200:203], v[224:227]
    v_mfma_f32_16x16x32_bf16 v[228:231], v[72:75], v[200:203], v[228:231]
    v_mfma_f32_16x16x32_bf16 v[224:227], v[44:47], v[204:207], v[224:227]
    v_mfma_f32_16x16x32_bf16 v[228:231], v[76:79], v[204:207], v[228:231]
    s_nop 6
    v_pk_mul_f32 v[224:225], v[224:225], v[212:213] op_sel_hi:[1,0]
    v_pk_mul_f32 v[226:227], v[226:227], v[212:213] op_sel_hi:[1,0]
    v_pk_mul_f32 v[228:229], v[228:229], v[212:213] op_sel_hi:[1,0]
    v_pk_mul_f32 v[230:231], v[230:231], v[212:213] op_sel_hi:[1,0]
    v_add_f32_dpp v224, v224, v224 row_ror:2 row_mask:0xf bank_mask:0xf
    v_add_f32_dpp v225, v225, v225 row_ror:2 row_mask:0xf bank_mask:0xf
    v_add_f32_dpp v226, v226, v226 row_ror:2 row_mask:0xf bank_mask:0xf
    v_add_f32_dpp v227, v227, v227 row_ror:2 row_mask:0xf bank_mask:0xf
    v_add_f32_dpp v228, v228, v228 row_ror:2 row_mask:0xf bank_mask:0xf
    v_add_f32_dpp v229, v229, v229 row_ror:2 row_mask:0xf bank_mask:0xf
    v_add_f32_dpp v230, v230, v230 row_ror:2 row_mask:0xf bank_mask:0xf
    v_add_f32_dpp v231, v231, v231 row_ror:2 row_mask:0xf bank_mask:0xf
    v_add_f32_dpp v224, v224, v224 row_ror:4 row_mask:0xf bank_mask:0xf
    v_add_f32_dpp v225, v225, v225 row_ror:4 row_mask:0xf bank_mask:0xf
    v_add_f32_dpp v226, v226, v226 row_ror:4 row_mask:0xf bank_mask:0xf
    v_add_f32_dpp v227, v227, v227 row_ror:4 row_mask:0xf bank_mask:0xf
    v_add_f32_dpp v228, v228, v228 row_ror:4 row_mask:0xf bank_mask:0xf
    v_add_f32_dpp v229, v229, v229 row_ror:4 row_mask:0xf bank_mask:0xf
    v_add_f32_dpp v230, v230, v230 row_ror:4 row_mask:0xf bank_mask:0xf
    v_add_f32_dpp v231, v231, v231 row_ror:4 row_mask:0xf bank_mask:0xf
    v_add_f32_dpp v224, v224, v224 row_ror:8 row_mask:0xf bank_mask:0xf
    v_add_f32_dpp v225, v225, v225 row_ror:8 row_mask:0xf bank_mask:0xf
    v_add_f32_dpp v226, v226, v226 row_ror:8 row_mask:0xf bank_mask:0xf
    v_add_f32_dpp v227, v227, v227 row_ror:8 row_mask:0xf bank_mask:0xf
    v_add_f32_dpp v228, v228, v228 row_ror:8 row_mask:0xf bank_mask:0xf
    v_add_f32_dpp v229, v229, v229 row_ror:8 row_mask:0xf bank_mask:0xf
    v_add_f32_dpp v230, v230, v230 row_ror:8 row_mask:0xf bank_mask:0xf
    v_add_f32_dpp v231, v231, v231 row_ror:8 row_mask:0xf bank_mask:0xf
    v_cndmask_b32 v224, v224, v128, s[28:29]
    v_cndmask_b32 v225, v225, v129, s[28:29]
    v_cndmask_b32 v226, v226, v130, s[28:29]
    v_cndmask_b32 v227, v227, v131, s[28:29]
    v_cndmask_b32 v228, v228, v132, s[28:29]
    v_cndmask_b32 v229, v229, v133, s[28:29]
    v_cndmask_b32 v230, v230, v134, s[28:29]
    v_cndmask_b32 v231, v231, v135, s[28:29]
    v_perm_b32 v224, v224, v234, s64
    v_perm_b32 v225, v225, v234, s65
    v_perm_b32 v226, v226, v234, s66
    v_perm_b32 v227, v227, v234, s67
    v_perm_b32 v228, v228, v234, s64
    v_perm_b32 v229, v229, v234, s65
    v_perm_b32 v230, v230, v234, s66
    v_perm_b32 v231, v231, v234, s67
    s_mov_b32 exec_lo, 0xf000f
    s_mov_b32 exec_hi, 0xf000f
    buffer_store_dwordx4 v[224:227], v6, s[44:47], s57 offen sc1
    buffer_store_dwordx4 v[228:231], v6, s[44:47], s50 offen sc1
    s_mov_b64 exec, -1
    s_cmp_eq_u32 s51, -1
    s_cbranch_scc1 L_D
L_gp_165:
    buffer_load_dwordx4 v[176:179], v8, s[44:47], s48 offen offset:0 sc1
    buffer_load_dwordx4 v[180:183], v8, s[44:47], s48 offen offset:1024 sc1
    buffer_load_dwordx4 v[184:187], v8, s[44:47], s48 offen offset:2048 sc1
    buffer_load_dwordx4 v[188:191], v8, s[44:47], s48 offen offset:3072 sc1
    s_waitcnt vmcnt(3)
    v_perm_b32 v244, v177, v176, s62
    v_perm_b32 v245, v179, v178, s63
    v_bitop3_b32 v12, v244, v245, v234 bitop3:0x56
    s_waitcnt vmcnt(2)
    v_perm_b32 v244, v181, v180, s62
    v_perm_b32 v245, v183, v182, s63
    v_bitop3_b32 v13, v244, v245, v234 bitop3:0x56
    v_or_b32 v12, v12, v13
    s_waitcnt vmcnt(1)
    v_perm_b32 v244, v185, v184, s62
    v_perm_b32 v245, v187, v186, s63
    v_bitop3_b32 v13, v244, v245, v234 bitop3:0x56
    v_or_b32 v12, v12, v13
    s_waitcnt vmcnt(0)
    v_perm_b32 v244, v189, v188, s62
    v_perm_b32 v245, v191, v190, s63
    v_bitop3_b32 v13, v244, v245, v234 bitop3:0x56
    v_or_b32 v12, v12, v13
    v_cmp_ne_u32 vcc, 0, v12
    s_cbranch_vccz L_gpd_166
    s_sub_u32 s52, s52, 1
    s_cbranch_scc1 L_timeout
    s_branch L_gp_165
L_gpd_166:
    v_and_b32 v176, s61, v176
    v_and_b32 v177, s61, v177
    v_and_b32 v178, s61, v178
    v_and_b32 v179, s61, v179
    v_and_b32 v180, s61, v180
    v_and_b32 v181, s61, v181
    v_and_b32 v182, s61, v182
    v_and_b32 v183, s61, v183
    v_and_b32 v184, s61, v184
    v_and_b32 v185, s61, v185
    v_and_b32 v186, s61, v186
    v_and_b32 v187, s61, v187
    v_and_b32 v188, s61, v188
    v_and_b32 v189, s61, v189
    v_and_b32 v190, s61, v190
    v_and_b32 v191, s61, v191
    v_pk_add_f32 v[176:177], v[176:177], v[180:181]
    v_pk_add_f32 v[178:179], v[178:179], v[182:183]
    v_pk_add_f32 v[184:185], v[184:185], v[188:189]
    v_pk_add_f32 v[186:187], v[186:187], v[190:191]
    v_pk_add_f32 v[176:177], v[176:177], v[184:185]
    v_pk_add_f32 v[178:179], v[178:179], v[186:187]
    s_nop 0
    v_add_f32_dpp v176, v176, v176 row_ror:8 row_mask:0xf bank_mask:0xf
    v_add_f32_dpp v177, v177, v177 row_ror:8 row_mask:0xf bank_mask:0xf
    v_add_f32_dpp v178, v178, v178 row_ror:8 row_mask:0xf bank_mask:0xf
    v_add_f32_dpp v179, v179, v179 row_ror:8 row_mask:0xf bank_mask:0xf
    v_permlane16_swap_b32 v176, v177
    s_nop 0
    v_permlane16_swap_b32 v178, v179
    v_add_f32 v176, v176, v177
    v_add_f32 v178, v178, v179
    s_nop 1
    v_permlane32_swap_b32 v176, v178
    v_add_f32 v176, v176, v178
    v_fma_f32 v176, v152, v176, v154
    v_mov_b32 v177, v176
    s_nop 1
    v_permlane16_swap_b32 v176, v177
    v_cvt_pk_bf16_f32 v232, v176, v177
    v_mov_b32 v233, v232
    s_nop 1
    v_permlane32_swap_b32 v232, v233
    buffer_store_dwordx4 v[232:235], v155, s[44:47], s49 offen sc1
    s_mov_b64 exec, -1
L_D:
    s_cmp_eq_u32 s79, -1
    s_cbranch_scc1 L_auxend
    s_lshl_b32 s7, s79, 3
    s_add_u32 s8, s32, s7
    s_addc_u32 s9, s33, 0
    s_mov_b32 s10, 1964832
    s_mov_b32 s11, 0x20000
    s_mul_i32 s7, s3, 12288
    s_add_u32 s7, s7, 84992
    s_mov_b32 m0, s7
    s_mul_i32 s57, s3, 491520
    s_add_u32 s57, s57, 204800
    buffer_load_dwordx4 v242, s[8:11], s57 offen nt lds
    s_add_u32 m0, m0, 1024
    s_add_u32 s57, s57, 40960
    buffer_load_dwordx4 v242, s[8:11], s57 offen nt lds
    s_add_u32 m0, m0, 1024
    s_add_u32 s57, s57, 40960
    buffer_load_dwordx4 v242, s[8:11], s57 offen nt lds
    s_add_u32 m0, m0, 1024
    s_add_u32 s57, s57, 40960
    buffer_load_dwordx4 v242, s[8:11], s57 offen nt lds
    s_add_u32 m0, m0, 1024
    s_add_u32 s57, s57, 40960
    buffer_load_dwordx4 v242, s[8:11], s57 offen nt lds
    s_add_u32 m0, m0, 1024
    s_add_u32 s57, s57, 40960
    buffer_load_dwordx4 v242, s[8:11], s57 offen nt lds
    s_add_u32 m0, m0, 1024
    s_add_u32 s57, s57, 40960
    buffer_load_dwordx4 v242, s[8:11], s57 offen nt lds
    s_lshl_b32 s56, s79, 6
    s_and_b32 s7, s56, 0x2000
    s_add_u32 s56, s56, s7
    s_add_u32 s56, s56, s27
    s_and_b32 s59, s74, 1
    s_mul_i32 s59, s59, 49152
    s_lshr_b32 s7, s74, 2
    s_xor_b32 s7, s7, s41
    s_lshl_b32 s7, s7, 13
    s_add_u32 s59, s59, s7
    s_add_u32 s59, s59, 2883584
    s_mul_i32 s58, s3, 6144
    s_add_u32 s68, s58, 0
    s_and_b32 s7, s68, 0x6000
    s_add_u32 s68, s68, s7
    s_add_u32 s68, s68, s59
    s_add_u32 s69, s58, 1024
    s_and_b32 s7, s69, 0x6000
    s_add_u32 s69, s69, s7
    s_add_u32 s69, s69, s59
    s_add_u32 s70, s58, 2048
    s_and_b32 s7, s70, 0x6000
    s_add_u32 s70, s70, s7
    s_add_u32 s70, s70, s59
    s_add_u32 s71, s58, 3072
    s_and_b32 s7, s71, 0x6000
    s_add_u32 s71, s71, s7
    s_add_u32 s71, s71, s59
    s_add_u32 s72, s58, 4096
    s_and_b32 s7, s72, 0x6000
    s_add_u32 s72, s72, s7
    s_add_u32 s72, s72, s59
    s_add_u32 s73, s58, 5120
    s_and_b32 s7, s73, 0x6000
    s_add_u32 s73, s73, s7
    s_add_u32 s73, s73, s59
    s_mov_b32 s60, 0xffffffff
    s_mov_b32 s61, 0xffffffff
L_gm_167:
    s_mov_b64 exec, s[60:61]
    buffer_load_dwordx3 v[160:162], v7, s[44:47], s56 offen offset:0 sc1
    s_waitcnt vmcnt(0)
    s_mov_b64 exec, s[60:61]
    v_cmp_ne_u32 s[60:61], s4, v162
    s_mov_b64 exec, -1
    s_or_b64 s[58:59], s[60:61], s[60:61]
    s_cbranch_scc0 L_gmd_168
    s_sub_u32 s52, s52, 1
    s_cbranch_scc1 L_timeout
    s_branch L_gm_167
L_gmd_168:
    ds_read_b64_tr_b16 v[80:81], v243 offset:0
    ds_read_b64_tr_b16 v[82:83], v243 offset:2048
    ds_read_b64_tr_b16 v[84:85], v243 offset:512
    ds_read_b64_tr_b16 v[86:87], v243 offset:2560
    ds_read_b64_tr_b16 v[88:89], v243 offset:1024
    ds_read_b64_tr_b16 v[90:91], v243 offset:3072
    ds_read_b64_tr_b16 v[92:93], v243 offset:1536
    ds_read_b64_tr_b16 v[94:95], v243 offset:3584
    ds_read_b64_tr_b16 v[96:97], v243 offset:4096
    ds_read_b64_tr_b16 v[98:99], v243 offset:6144
    ds_read_b64_tr_b16 v[100:101], v243 offset:4608
    ds_read_b64_tr_b16 v[102:103], v243 offset:6656
    ds_read_b64_tr_b16 v[104:105], v243 offset:5120
    ds_read_b64_tr_b16 v[106:107], v243 offset:7168
    ds_read_b64_tr_b16 v[108:109], v243 offset:5632
    ds_read_b64_tr_b16 v[110:111], v243 offset:7680
    ds_read_b64_tr_b16 v[112:113], v243 offset:8192
    ds_read_b64_tr_b16 v[114:115], v243 offset:10240
    ds_read_b64_tr_b16 v[116:117], v243 offset:8704
    ds_read_b64_tr_b16 v[118:119], v243 offset:10752
    ds_read_b64_tr_b16 v[120:121], v243 offset:9216
    ds_read_b64_tr_b16 v[122:123], v243 offset:11264
    ds_read_b64_tr_b16 v[124:125], v243 offset:9728
    ds_read_b64_tr_b16 v[126:127], v243 offset:11776
    v_lshlrev_b32 v164, 16, v160
    v_and_b32 v165, s53, v160
    v_lshlrev_b32 v166, 16, v161
    v_and_b32 v167, s53, v161
    s_lshl_b32 s56, s79, 3
L_gf_169:
    buffer_load_dwordx3 v[176:178], v9, s[44:47], s68 offen offset:0 sc1
    buffer_load_dwordx3 v[180:182], v9, s[44:47], s69 offen offset:0 sc1
    buffer_load_dwordx3 v[184:186], v9, s[44:47], s70 offen offset:0 sc1
    buffer_load_dwordx3 v[188:190], v9, s[44:47], s71 offen offset:0 sc1
    buffer_load_dwordx3 v[192:194], v9, s[44:47], s72 offen offset:0 sc1
    buffer_load_dwordx3 v[196:198], v9, s[44:47], s73 offen offset:0 sc1
    s_waitcnt vmcnt(4)
    v_min_u32 v12, v178, v182
    v_max_u32 v13, v178, v182
    s_waitcnt vmcnt(2)
    v_min3_u32 v12, v12, v186, v190
    v_max3_u32 v13, v13, v186, v190
    s_waitcnt vmcnt(0)
    v_min3_u32 v12, v12, v194, v198
    v_max3_u32 v13, v13, v194, v198
    v_cmp_ne_u32 s[58:59], s4, v12
    v_cmp_ne_u32 vcc, s4, v13
    s_nop 0
    s_or_b64 s[58:59], s[58:59], vcc
    s_cbranch_scc0 L_gfd_170
    s_sub_u32 s52, s52, 1
    s_cbranch_scc1 L_timeout
    s_branch L_gf_169
L_gfd_170:
    s_waitcnt lgkmcnt(0)
    v_mov_b32 v200, v176
    v_mov_b32 v201, v177
    v_mov_b32 v202, v180
    v_mov_b32 v203, v181
    v_mov_b32_dpp v204, v176 row_shl:4 row_mask:0xf bank_mask:0xf
    v_mov_b32_dpp v205, v177 row_shl:4 row_mask:0xf bank_mask:0xf
    v_mov_b32_dpp v206, v180 row_shl:4 row_mask:0xf bank_mask:0xf
    v_mov_b32_dpp v207, v181 row_shl:4 row_mask:0xf bank_mask:0xf
    v_mfma_f32_16x16x32_bf16 v[224:227], v[80:83], v[200:203], 0
    v_mov_b32_dpp v208, v176 row_shl:8 row_mask:0xf bank_mask:0xf
    v_mov_b32_dpp v209, v177 row_shl:8 row_mask:0xf bank_mask:0xf
    v_mov_b32_dpp v210, v180 row_shl:8 row_mask:0xf bank_mask:0xf
    v_mov_b32_dpp v211, v181 row_shl:8 row_mask:0xf bank_mask:0xf
    v_mfma_f32_16x16x32_bf16 v[228:231], v[84:87], v[204:207], 0
    v_mov_b32_dpp v212, v176 row_shl:12 row_mask:0xf bank_mask:0xf
    v_mov_b32_dpp v213, v177 row_shl:12 row_mask:0xf bank_mask:0xf
    v_mov_b32_dpp v214, v180 row_shl:12 row_mask:0xf bank_mask:0xf
    v_mov_b32_dpp v215, v181 row_shl:12 row_mask:0xf bank_mask:0xf
    v_mfma_f32_16x16x32_bf16 v[224:227], v[88:91], v[208:211], v[224:227]
    v_mov_b32 v200, v184
    v_mov_b32 v201, v185
    v_mov_b32 v202, v188
    v_mov_b32 v203, v189
    v_mfma_f32_16x16x32_bf16 v[228:231], v[92:95], v[212:215], v[228:231]
    v_mov_b32_dpp v204, v184 row_shl:4 row_mask:0xf bank_mask:0xf
    v_mov_b32_dpp v205, v185 row_shl:4 row_mask:0xf bank_mask:0xf
    v_mov_b32_dpp v206, v188 row_shl:4 row_mask:0xf bank_mask:0xf
    v_mov_b32_dpp v207, v189 row_shl:4 row_mask:0xf bank_mask:0xf
    v_mfma_f32_16x16x32_bf16 v[224:227], v[96:99], v[200:203], v[224:227]
    v_mov_b32_dpp v208, v184 row_shl:8 row_mask:0xf bank_mask:0xf
    v_mov_b32_dpp v209, v185 row_shl:8 row_mask:0xf bank_mask:0xf
    v_mov_b32_dpp v210, v188 row_shl:8 row_mask:0xf bank_mask:0xf
    v_mov_b32_dpp v211, v189 row_shl:8 row_mask:0xf bank_mask:0xf
    v_mfma_f32_16x16x32_bf16 v[228:231], v[100:103], v[204:207], v[228:231]
    v_mov_b32_dpp v212, v184 row_shl:12 row_mask:0xf bank_mask:0xf
    v_mov_b32_dpp v213, v185 row_shl:12 row_mask:0xf bank_mask:0xf
    v_mov_b32_dpp v214, v188 row_shl:12 row_mask:0xf bank_mask:0xf
    v_mov_b32_dpp v215, v189 row_shl:12 row_mask:0xf bank_mask:0xf
    v_mfma_f32_16x16x32_bf16 v[224:227], v[104:107], v[208:211], v[224:227]
    v_mov_b32 v200, v192
    v_mov_b32 v201, v193
    v_mov_b32 v202, v196
    v_mov_b32 v203, v197
    v_mfma_f32_16x16x32_bf16 v[228:231], v[108:111], v[212:215], v[228:231]
    v_mov_b32_dpp v204, v192 row_shl:4 row_mask:0xf bank_mask:0xf
    v_mov_b32_dpp v205, v193 row_shl:4 row_mask:0xf bank_mask:0xf
    v_mov_b32_dpp v206, v196 row_shl:4 row_mask:0xf bank_mask:0xf
    v_mov_b32_dpp v207, v197 row_shl:4 row_mask:0xf bank_mask:0xf
    v_mfma_f32_16x16x32_bf16 v[224:227], v[112:115], v[200:203], v[224:227]
    v_mov_b32_dpp v208, v192 row_shl:8 row_mask:0xf bank_mask:0xf
    v_mov_b32_dpp v209, v193 row_shl:8 row_mask:0xf bank_mask:0xf
    v_mov_b32_dpp v210, v196 row_shl:8 row_mask:0xf bank_mask:0xf
    v_mov_b32_dpp v211, v197 row_shl:8 row_mask:0xf bank_mask:0xf
    v_mfma_f32_16x16x32_bf16 v[228:231], v[116:119], v[204:207], v[228:231]
    v_mov_b32_dpp v212, v192 row_shl:12 row_mask:0xf bank_mask:0xf
    v_mov_b32_dpp v213, v193 row_shl:12 row_mask:0xf bank_mask:0xf
    v_mov_b32_dpp v214, v196 row_shl:12 row_mask:0xf bank_mask:0xf
    v_mov_b32_dpp v215, v197 row_shl:12 row_mask:0xf bank_mask:0xf
    v_mfma_f32_16x16x32_bf16 v[224:227], v[120:123], v[208:211], v[224:227]
    s_nop 0
    v_mfma_f32_16x16x32_bf16 v[228:231], v[124:127], v[212:215], v[228:231]
    s_mov_b32 exec_lo, 0xf000f
    s_mov_b32 exec_hi, 0xf000f
    s_nop 5
    v_pk_add_f32 v[224:225], v[224:225], v[228:229]
    v_pk_add_f32 v[226:227], v[226:227], v[230:231]
    ds_write_b128 v251, v[224:227]
    s_waitcnt lgkmcnt(0)
    s_barrier
    s_cmp_lg_u32 s3, 0
    s_cbranch_scc1 L_auxend
    ds_read_b128 v[180:183], v250 offset:256
    ds_read_b128 v[184:187], v250 offset:512
    ds_read_b128 v[188:191], v250 offset:768
    s_waitcnt lgkmcnt(1)
    v_pk_add_f32 v[224:225], v[224:225], v[180:181]
    v_pk_add_f32 v[226:227], v[226:227], v[182:183]
    s_waitcnt lgkmcnt(0)
    v_pk_add_f32 v[184:185], v[184:185], v[188:189]
    v_pk_add_f32 v[186:187], v[186:187], v[190:191]
    v_pk_add_f32 v[224:225], v[224:225], v[184:185]
    v_pk_add_f32 v[226:227], v[226:227], v[186:187]
    v_pk_fma_f32 v[224:225], v[224:225], v[156:157], v[164:165]
    v_pk_fma_f32 v[226:227], v[226:227], v[158:159], v[166:167]
    v_cvt_pk_bf16_f32 v176, v224, v225
    v_cvt_pk_bf16_f32 v177, v226, v227
    buffer_store_dwordx2 v[176:177], v11, s[12:15], s56 offen
    s_cmp_lg_u32 s79, 0
    s_cbranch_scc1 L_auxend
    s_mov_b32 exec_lo, 0x1
    s_mov_b32 exec_hi, 0x0
    buffer_store_dword v234, v8, s[44:47], 0 offen
L_auxend:
    s_mov_b64 exec, -1
    s_add_u32 s3, s3, 4
    s_endpgm
L_gprep:
    v_and_b32 v11, 12, v2
    v_add_u32 v11, v11, v3
    v_lshlrev_b32 v8, 6, v11
    v_lshl_add_u32 v8, v15, 4, v8
    v_mov_b32 v249, v8
    s_lshl_b32 s7, s3, 10
    v_add_u32 v8, s7, v8
    s_cmp_lt_u32 s3, 2
    s_cselect_b32 s7, 2, 1
    s_lshl_b32 s7, s7, 12
    v_add_u32 v9, 4096, v8
    v_add_u32 v10, s7, v8
    s_mov_b32 s56, 34816
    s_mov_b32 s57, 45056
    s_mov_b32 s60, 0xffffffff
    s_mov_b32 s61, 0xffffffff
    s_mov_b64 s[62:63], s[60:61]
    s_mov_b64 s[64:65], s[60:61]
    s_mov_b64 s[66:67], s[60:61]
    s_mov_b64 s[68:69], s[60:61]
    s_mov_b64 s[70:71], s[60:61]
L_gm_173:
    s_mov_b64 exec, s[60:61]
    buffer_load_dwordx3 v[176:178], v8, s[44:47], s56 offen offset:0 sc1
    s_mov_b64 exec, s[62:63]
    buffer_load_dwordx3 v[180:182], v9, s[44:47], s56 offen offset:0 sc1
    s_mov_b64 exec, s[64:65]
    buffer_load_dwordx3 v[184:186], v10, s[44:47], s56 offen offset:0 sc1
    s_mov_b64 exec, s[66:67]
    buffer_load_dwordx3 v[188:190], v8, s[44:47], s57 offen offset:0 sc1
    s_mov_b64 exec, s[68:69]
    buffer_load_dwordx3 v[192:194], v9, s[44:47], s57 offen offset:0 sc1
    s_mov_b64 exec, s[70:71]
    buffer_load_dwordx3 v[196:198], v10, s[44:47], s57 offen offset:0 sc1
    s_waitcnt vmcnt(5)
    s_mov_b64 exec, s[60:61]
    v_cmp_ne_u32 s[60:61], s4, v178
    s_waitcnt vmcnt(4)
    s_mov_b64 exec, s[62:63]
    v_cmp_ne_u32 s[62:63], s4, v182
    s_waitcnt vmcnt(3)
    s_mov_b64 exec, s[64:65]
    v_cmp_ne_u32 s[64:65], s4, v186
    s_waitcnt vmcnt(2)
    s_mov_b64 exec, s[66:67]
    v_cmp_ne_u32 s[66:67], s4, v190
    s_waitcnt vmcnt(1)
    s_mov_b64 exec, s[68:69]
    v_cmp_ne_u32 s[68:69], s4, v194
    s_waitcnt vmcnt(0)
    s_mov_b64 exec, s[70:71]
    v_cmp_ne_u32 s[70:71], s4, v198
    s_mov_b64 exec, -1
    s_or_b64 s[58:59], s[60:61], s[62:63]
    s_or_b64 s[58:59], s[58:59], s[64:65]
    s_or_b64 s[58:59], s[58:59], s[66:67]
    s_or_b64 s[58:59], s[58:59], s[68:69]
    s_or_b64 s[58:59], s[58:59], s[70:71]
    s_cbranch_scc0 L_gmd_174
    s_sub_u32 s52, s52, 1
    s_cbranch_scc1 L_timeout
    s_sleep 8
    s_branch L_gm_173
L_gmd_174:
    v_lshlrev_b32 v152, 16, v188
    v_and_b32 v153, s53, v188
    v_lshlrev_b32 v154, 16, v189
    v_and_b32 v155, s53, v189
    v_add_f32 v152, 1.0, v152
    v_add_f32 v153, 1.0, v153
    v_add_f32 v154, 1.0, v154
    v_add_f32 v155, 1.0, v155
    v_cvt_pk_bf16_f32 v188, v152, v153
    v_cvt_pk_bf16_f32 v189, v154, v155
    v_lshlrev_b32 v152, 16, v188
    v_and_b32 v153, s53, v188
    v_lshlrev_b32 v154, 16, v189
    v_and_b32 v155, s53, v189
    v_mov_b32 v46, 0
    s_nop 1
    v_mov_b32_dpp v46, v188 row_shr:4 row_mask:0xf bank_mask:0x2
    s_nop 1
    v_mov_b32_dpp v46, v176 row_shr:8 row_mask:0xf bank_mask:0x4
    v_mov_b32 v47, 0
    s_nop 1
    v_mov_b32_dpp v47, v189 row_shr:4 row_mask:0xf bank_mask:0x2
    s_nop 1
    v_mov_b32_dpp v47, v177 row_shr:8 row_mask:0xf bank_mask:0x4
    v_mov_b32 v48, 0
    s_nop 1
    v_mov_b32_dpp v48, v188 quad_perm:[0,1,2,3] row_mask:0xf bank_mask:0x2
    s_nop 1
    v_mov_b32_dpp v48, v176 row_shr:4 row_mask:0xf bank_mask:0x4
    v_mov_b32 v49, 0
    s_nop 1
    v_mov_b32_dpp v49, v189 quad_perm:[0,1,2,3] row_mask:0xf bank_mask:0x2
    s_nop 1
    v_mov_b32_dpp v49, v177 row_shr:4 row_mask:0xf bank_mask:0x4
    v_mov_b32 v50, 0
    s_nop 1
    v_mov_b32_dpp v50, v188 row_shl:4 row_mask:0xf bank_mask:0x2
    s_nop 1
    v_mov_b32_dpp v50, v176 quad_perm:[0,1,2,3] row_mask:0xf bank_mask:0x4
    v_mov_b32 v51, 0
    s_nop 1
    v_mov_b32_dpp v51, v189 row_shl:4 row_mask:0xf bank_mask:0x2
    s_nop 1
    v_mov_b32_dpp v51, v177 quad_perm:[0,1,2,3] row_mask:0xf bank_mask:0x4
    v_mov_b32 v52, 0
    s_nop 1
    v_mov_b32_dpp v52, v188 row_shl:8 row_mask:0xf bank_mask:0x2
    s_nop 1
    v_mov_b32_dpp v52, v176 row_shl:4 row_mask:0xf bank_mask:0x4
    v_mov_b32 v53, 0
    s_nop 1
    v_mov_b32_dpp v53, v189 row_shl:8 row_mask:0xf bank_mask:0x2
    s_nop 1
    v_mov_b32_dpp v53, v177 row_shl:4 row_mask:0xf bank_mask:0x4
    v_lshlrev_b32 v156, 16, v192
    v_and_b32 v157, s53, v192
    v_lshlrev_b32 v158, 16, v193
    v_and_b32 v159, s53, v193
    v_add_f32 v156, 1.0, v156
    v_add_f32 v157, 1.0, v157
    v_add_f32 v158, 1.0, v158
    v_add_f32 v159, 1.0, v159
    v_cvt_pk_bf16_f32 v192, v156, v157
    v_cvt_pk_bf16_f32 v193, v158, v159
    v_lshlrev_b32 v156, 16, v192
    v_and_b32 v157, s53, v192
    v_lshlrev_b32 v158, 16, v193
    v_and_b32 v159, s53, v193
    v_mov_b32 v54, 0
    s_nop 1
    v_mov_b32_dpp v54, v192 row_shr:4 row_mask:0xf bank_mask:0x2
    s_nop 1
    v_mov_b32_dpp v54, v180 row_shr:8 row_mask:0xf bank_mask:0x4
    v_mov_b32 v55, 0
    s_nop 1
    v_mov_b32_dpp v55, v193 row_shr:4 row_mask:0xf bank_mask:0x2
    s_nop 1
    v_mov_b32_dpp v55, v181 row_shr:8 row_mask:0xf bank_mask:0x4
    v_mov_b32 v56, 0
    s_nop 1
    v_mov_b32_dpp v56, v192 quad_perm:[0,1,2,3] row_mask:0xf bank_mask:0x2
    s_nop 1
    v_mov_b32_dpp v56, v180 row_shr:4 row_mask:0xf bank_mask:0x4
    v_mov_b32 v57, 0
    s_nop 1
    v_mov_b32_dpp v57, v193 quad_perm:[0,1,2,3] row_mask:0xf bank_mask:0x2
    s_nop 1
    v_mov_b32_dpp v57, v181 row_shr:4 row_mask:0xf bank_mask:0x4
    v_mov_b32 v58, 0
    s_nop 1
    v_mov_b32_dpp v58, v192 row_shl:4 row_mask:0xf bank_mask:0x2
    s_nop 1
    v_mov_b32_dpp v58, v180 quad_perm:[0,1,2,3] row_mask:0xf bank_mask:0x4
    v_mov_b32 v59, 0
    s_nop 1
    v_mov_b32_dpp v59, v193 row_shl:4 row_mask:0xf bank_mask:0x2
    s_nop 1
    v_mov_b32_dpp v59, v181 quad_perm:[0,1,2,3] row_mask:0xf bank_mask:0x4
    v_mov_b32 v60, 0
    s_nop 1
    v_mov_b32_dpp v60, v192 row_shl:8 row_mask:0xf bank_mask:0x2
    s_nop 1
    v_mov_b32_dpp v60, v180 row_shl:4 row_mask:0xf bank_mask:0x4
    v_mov_b32 v61, 0
    s_nop 1
    v_mov_b32_dpp v61, v193 row_shl:8 row_mask:0xf bank_mask:0x2
    s_nop 1
    v_mov_b32_dpp v61, v181 row_shl:4 row_mask:0xf bank_mask:0x4
    v_lshlrev_b32 v160, 16, v196
    v_and_b32 v161, s53, v196
    v_lshlrev_b32 v162, 16, v197
    v_and_b32 v163, s53, v197
    v_add_f32 v160, 1.0, v160
    v_add_f32 v161, 1.0, v161
    v_add_f32 v162, 1.0, v162
    v_add_f32 v163, 1.0, v163
    v_cvt_pk_bf16_f32 v196, v160, v161
    v_cvt_pk_bf16_f32 v197, v162, v163
    v_lshlrev_b32 v160, 16, v196
    v_and_b32 v161, s53, v196
    v_lshlrev_b32 v162, 16, v197
    v_and_b32 v163, s53, v197
    v_mov_b32 v62, 0
    s_nop 1
    v_mov_b32_dpp v62, v196 row_shr:4 row_mask:0xf bank_mask:0x2
    s_nop 1
    v_mov_b32_dpp v62, v184 row_shr:8 row_mask:0xf bank_mask:0x4
    v_mov_b32 v63, 0
    s_nop 1
    v_mov_b32_dpp v63, v197 row_shr:4 row_mask:0xf bank_mask:0x2
    s_nop 1
    v_mov_b32_dpp v63, v185 row_shr:8 row_mask:0xf bank_mask:0x4
    v_mov_b32 v64, 0
    s_nop 1
    v_mov_b32_dpp v64, v196 quad_perm:[0,1,2,3] row_mask:0xf bank_mask:0x2
    s_nop 1
    v_mov_b32_dpp v64, v184 row_shr:4 row_mask:0xf bank_mask:0x4
    v_mov_b32 v65, 0
    s_nop 1
    v_mov_b32_dpp v65, v197 quad_perm:[0,1,2,3] row_mask:0xf bank_mask:0x2
    s_nop 1
    v_mov_b32_dpp v65, v185 row_shr:4 row_mask:0xf bank_mask:0x4
    v_mov_b32 v66, 0
    s_nop 1
    v_mov_b32_dpp v66, v196 row_shl:4 row_mask:0xf bank_mask:0x2
    s_nop 1
    v_mov_b32_dpp v66, v184 quad_perm:[0,1,2,3] row_mask:0xf bank_mask:0x4
    v_mov_b32 v67, 0
    s_nop 1
    v_mov_b32_dpp v67, v197 row_shl:4 row_mask:0xf bank_mask:0x2
    s_nop 1
    v_mov_b32_dpp v67, v185 quad_perm:[0,1,2,3] row_mask:0xf bank_mask:0x4
    v_mov_b32 v68, 0
    s_nop 1
    v_mov_b32_dpp v68, v196 row_shl:8 row_mask:0xf bank_mask:0x2
    s_nop 1
    v_mov_b32_dpp v68, v184 row_shl:4 row_mask:0xf bank_mask:0x4
    v_mov_b32 v69, 0
    s_nop 1
    v_mov_b32_dpp v69, v197 row_shl:8 row_mask:0xf bank_mask:0x2
    s_nop 1
    v_mov_b32_dpp v69, v185 row_shl:4 row_mask:0xf bank_mask:0x4
    v_lshrrev_b32 v4, 1, v1
    v_lshlrev_b32 v4, 7, v4
    v_and_b32 v12, 1, v1
    v_lshl_add_u32 v4, v12, 4, v4
    v_lshlrev_b32 v6, 3, v15
    v_add_u32 v6, 144384, v6
    s_lshl_b32 s7, s3, 5
    v_lshl_add_u32 v5, v3, 2, v6
    v_add_u32 v5, s7, v5
    v_lshlrev_b32 v7, 6, v3
    v_lshl_add_u32 v7, v15, 4, v7
    v_add_u32 v7, 142336, v7
    v_lshlrev_b32 v248, 4, v1
    s_lshl_b32 s7, s3, 10
    v_add_u32 v252, s7, v248
    s_lshl_b32 s48, s78, 8
    s_and_b32 s7, s48, 0x6000
    s_add_u32 s48, s48, s7
    s_add_u32 s48, s48, 2883584
    v_subrev_u32 v11, 142336, v7
    v_bfe_u32 v12, v1, 2, 1
    v_mul_u32_u24 v12, 49152, v12
    v_add_u32 v11, v11, v12
    v_bfe_u32 v12, v1, 3, 1
    v_xor_b32 v12, s41, v12
    v_lshl_add_u32 v11, v12, 13, v11
    s_mov_b32 s51, 0xbdd2d3e8
    v_mov_b32 v253, 0xc0135761
L_gprep2:
    s_cmp_lt_u32 s3, 2
    s_cselect_b32 s8, s28, s30
    s_cselect_b32 s9, s29, s31
    s_lshl_b32 s7, s78, 5
    s_add_u32 s8, s8, s7
    s_addc_u32 s9, s9, 0
    s_mov_b32 s10, 1963040
    s_mov_b32 s11, 0x20000
    v_lshrrev_b32 v250, 1, v1
    v_mul_u32_u24 v250, 3072, v250
    v_and_b32 v12, 1, v1
    v_lshl_add_u32 v250, v12, 4, v250
    v_lshrrev_b32 v251, 2, v1
    v_lshlrev_b32 v251, 5, v251
    v_lshl_add_u32 v251, v15, 3, v251
    s_lshl_b32 s7, s3, 11
    s_add_u32 s7, s7, 30720
    v_add_u32 v251, s7, v251
    s_mov_b32 s61, 0xffffff00
    s_mov_b32 s62, 0x0c0c0400
    s_mov_b32 s63, 0x04000c0c
    s_mov_b32 s64, 0x07060500
    s_mov_b32 s65, 0x07060501
    s_mov_b32 s66, 0x07060502
    s_mov_b32 s67, 0x07060503
    s_cmp_lg_u32 s3, 2
    s_cbranch_scc1 L_am_175
    v_lshrrev_b32 v216, 5, v1
    v_mul_u32_u24 v216, 768, v216
    v_and_b32 v217, 31, v1
    v_mul_u32_u24 v217, 24, v217
    v_add_u32 v216, v216, v217
    v_mov_b32 v217, 146176
    v_lshlrev_b32 v218, 4, v1
    s_lshl_b32 s58, s5, 5
    s_add_u32 s58, s58, s6
    s_lshl_b32 s58, s58, 10
    s_add_u32 s58, s58, 4194304
    s_and_b32 s59, s4, 0xbfffbfff
L_lw_176:
    ds_read_b32 v13, v14 offset:32
    s_waitcnt lgkmcnt(0)
    v_readfirstlane_b32 s7, v13
    s_nop 0
    s_cmp_ge_u32 s7, 4
    s_cbranch_scc1 L_lwd_177
    s_sub_u32 s52, s52, 1
    s_cbranch_scc1 L_timeout
    s_sleep 4
    s_branch L_lw_176
L_lwd_177:
    ds_read_b32 v12, v14 offset:0
    ds_read_b128 v[176:179], v217
    ds_read_b128 v[180:183], v217 offset:16
    ds_read_b64 v[184:185], v216 offset:0
    ds_read_b64 v[186:187], v216 offset:8
    ds_read_b64 v[188:189], v216 offset:16
    ds_read_b64 v[190:191], v216 offset:1536
    ds_read_b64 v[192:193], v216 offset:1544
    ds_read_b64 v[194:195], v216 offset:1552
    ds_read_b64 v[196:197], v216 offset:3072
    ds_read_b64 v[198:199], v216 offset:3080
    ds_read_b64 v[200:201], v216 offset:3088
    ds_read_b64 v[202:203], v216 offset:4608
    ds_read_b64 v[204:205], v216 offset:4616
    ds_read_b64 v[206:207], v216 offset:4624
    s_waitcnt lgkmcnt(14)
    v_readfirstlane_b32 s40, v12
    s_waitcnt lgkmcnt(12)
    v_max3_f32 v208, v176, v178, v180
    v_max_f32 v208, v208, v182
    v_sub_f32 v176, v176, v208
    v_sub_f32 v178, v178, v208
    v_sub_f32 v180, v180, v208
    v_sub_f32 v182, v182, v208
    v_exp_f32 v176, v176
    v_exp_f32 v178, v178
    v_exp_f32 v180, v180
    v_exp_f32 v182, v182
    v_mul_f32 v209, v176, v177
    v_fmac_f32 v209, v178, v179
    v_fmac_f32 v209, v180, v181
    v_fmac_f32 v209, v182, v183
    v_rcp_f32 v210, v209
    s_waitcnt lgkmcnt(0)
    v_pk_mul_f32 v[184:185], v[184:185], v[176:177] op_sel_hi:[1,0]
    v_pk_mul_f32 v[186:187], v[186:187], v[176:177] op_sel_hi:[1,0]
    v_pk_mul_f32 v[188:189], v[188:189], v[176:177] op_sel_hi:[1,0]
    v_pk_fma_f32 v[184:185], v[190:191], v[178:179], v[184:185] op_sel_hi:[1,0,1]
    v_pk_fma_f32 v[186:187], v[192:193], v[178:179], v[186:187] op_sel_hi:[1,0,1]
    v_pk_fma_f32 v[188:189], v[194:195], v[178:179], v[188:189] op_sel_hi:[1,0,1]
    v_pk_fma_f32 v[184:185], v[196:197], v[180:181], v[184:185] op_sel_hi:[1,0,1]
    v_pk_fma_f32 v[186:187], v[198:199], v[180:181], v[186:187] op_sel_hi:[1,0,1]
    v_pk_fma_f32 v[188:189], v[200:201], v[180:181], v[188:189] op_sel_hi:[1,0,1]
    v_pk_fma_f32 v[184:185], v[202:203], v[182:183], v[184:185] op_sel_hi:[1,0,1]
    v_pk_fma_f32 v[186:187], v[204:205], v[182:183], v[186:187] op_sel_hi:[1,0,1]
    v_pk_fma_f32 v[188:189], v[206:207], v[182:183], v[188:189] op_sel_hi:[1,0,1]
    v_permlane32_swap_b32 v184, v185
    v_permlane32_swap_b32 v186, v187
    v_permlane32_swap_b32 v188, v189
    v_add_f32 v184, v184, v185
    v_add_f32 v186, v186, v187
    v_add_f32 v188, v188, v189
    v_mul_f32 v184, v210, v184
    v_mul_f32 v186, v210, v186
    v_mul_f32 v188, v210, v188
    v_mov_b32 v185, v184
    v_mov_b32 v187, v186
    v_mov_b32 v189, v188
    v_permlane32_swap_b32 v184, v185
    v_permlane32_swap_b32 v186, v187
    v_permlane32_swap_b32 v188, v189
    v_cvt_pk_bf16_f32 v212, v184, v185
    v_cvt_pk_bf16_f32 v213, v186, v187
    v_cvt_pk_bf16_f32 v214, v188, v189
    v_mov_b32 v215, s59
    s_mov_b32 exec_lo, 0
    s_mov_b32 exec_hi, 1
    v_mov_b32 v212, v208
    v_mov_b32 v213, v209
    s_mov_b32 exec_lo, -1
    s_cmp_eq_u32 s40, 0
    s_cbranch_scc1 L_s2_178
    buffer_store_dwordx4 v[212:215], v218, s[44:47], s58 offen
    s_branch L_s2e_179
L_s2_178:
    s_nop 7
    buffer_store_dwordx4 v[212:215], v218, s[44:47], s58 offen sc1
L_s2e_179:
    s_mov_b64 exec, -1
L_am_175:
    s_mul_i32 s56, s3, 10240
    s_add_u32 s56, s56, 30720
    s_mov_b32 m0, s56
    s_and_b32 s57, s3, 1
    s_mul_i32 s57, s57, 983040
L_lw_180:
    ds_read_b32 v13, v14 offset:24
    s_waitcnt lgkmcnt(0)
    v_readfirstlane_b32 s7, v13
    s_nop 0
    s_cmp_ge_u32 s7, 44
    s_cbranch_scc1 L_lwd_181
    s_sub_u32 s52, s52, 1
    s_cbranch_scc1 L_timeout
    s_sleep 4
    s_branch L_lw_180
L_lwd_181:
    buffer_load_dwordx4 v250, s[8:11], s57 offen nt lds
    s_add_u32 m0, m0, 1024
    s_add_u32 s57, s57, 98304
    s_waitcnt vmcnt(0)
    buffer_load_dwordx4 v250, s[8:11], s57 offen nt lds
    s_add_u32 m0, m0, 1024
    s_add_u32 s57, s57, 98304
    s_waitcnt vmcnt(0)
    buffer_load_dwordx4 v250, s[8:11], s57 offen nt lds
    s_add_u32 m0, m0, 1024
    s_add_u32 s57, s57, 98304
    s_waitcnt vmcnt(0)
    buffer_load_dwordx4 v250, s[8:11], s57 offen nt lds
    s_add_u32 m0, m0, 1024
    s_add_u32 s57, s57, 98304
    s_waitcnt vmcnt(0)
    buffer_load_dwordx4 v250, s[8:11], s57 offen nt lds
    s_add_u32 m0, m0, 1024
    s_add_u32 s57, s57, 98304
    s_waitcnt vmcnt(0)
    buffer_load_dwordx4 v250, s[8:11], s57 offen nt lds
    s_add_u32 m0, m0, 1024
    s_add_u32 s57, s57, 98304
    s_cmp_lg_u32 s3, 2
    s_cbranch_scc1 L_am_182
    v_lshrrev_b32 v216, 5, v1
    v_mul_u32_u24 v216, 768, v216
    v_and_b32 v217, 31, v1
    v_mul_u32_u24 v217, 24, v217
    v_add_u32 v216, v216, v217
    v_mov_b32 v217, 146208
    v_lshlrev_b32 v218, 4, v1
    s_lshl_b32 s58, s5, 5
    s_add_u32 s58, s58, s6
    s_lshl_b32 s58, s58, 10
    s_add_u32 s58, s58, 4202496
    s_and_b32 s59, s4, 0xbfffbfff
L_lw_183:
    ds_read_b32 v13, v14 offset:36
    s_waitcnt lgkmcnt(0)
    v_readfirstlane_b32 s7, v13
    s_nop 0
    s_cmp_ge_u32 s7, 4
    s_cbranch_scc1 L_lwd_184
    s_sub_u32 s52, s52, 1
    s_cbranch_scc1 L_timeout
    s_sleep 4
    s_branch L_lw_183
L_lwd_184:
    ds_read_b32 v12, v14 offset:0
    ds_read_b128 v[176:179], v217
    ds_read_b128 v[180:183], v217 offset:16
    ds_read_b64 v[184:185], v216 offset:6144
    ds_read_b64 v[186:187], v216 offset:6152
    ds_read_b64 v[188:189], v216 offset:6160
    ds_read_b64 v[190:191], v216 offset:7680
    ds_read_b64 v[192:193], v216 offset:7688
    ds_read_b64 v[194:195], v216 offset:7696
    ds_read_b64 v[196:197], v216 offset:9216
    ds_read_b64 v[198:199], v216 offset:9224
    ds_read_b64 v[200:201], v216 offset:9232
    ds_read_b64 v[202:203], v216 offset:10752
    ds_read_b64 v[204:205], v216 offset:10760
    ds_read_b64 v[206:207], v216 offset:10768
    s_waitcnt lgkmcnt(14)
    v_readfirstlane_b32 s40, v12
    s_waitcnt lgkmcnt(12)
    v_max3_f32 v208, v176, v178, v180
    v_max_f32 v208, v208, v182
    v_sub_f32 v176, v176, v208
    v_sub_f32 v178, v178, v208
    v_sub_f32 v180, v180, v208
    v_sub_f32 v182, v182, v208
    v_exp_f32 v176, v176
    v_exp_f32 v178, v178
    v_exp_f32 v180, v180
    v_exp_f32 v182, v182
    v_mul_f32 v209, v176, v177
    v_fmac_f32 v209, v178, v179
    v_fmac_f32 v209, v180, v181
    v_fmac_f32 v209, v182, v183
    v_rcp_f32 v210, v209
    s_waitcnt lgkmcnt(0)
    v_pk_mul_f32 v[184:185], v[184:185], v[176:177] op_sel_hi:[1,0]
    v_pk_mul_f32 v[186:187], v[186:187], v[176:177] op_sel_hi:[1,0]
    v_pk_mul_f32 v[188:189], v[188:189], v[176:177] op_sel_hi:[1,0]
    v_pk_fma_f32 v[184:185], v[190:191], v[178:179], v[184:185] op_sel_hi:[1,0,1]
    v_pk_fma_f32 v[186:187], v[192:193], v[178:179], v[186:187] op_sel_hi:[1,0,1]
    v_pk_fma_f32 v[188:189], v[194:195], v[178:179], v[188:189] op_sel_hi:[1,0,1]
    v_pk_fma_f32 v[184:185], v[196:197], v[180:181], v[184:185] op_sel_hi:[1,0,1]
    v_pk_fma_f32 v[186:187], v[198:199], v[180:181], v[186:187] op_sel_hi:[1,0,1]
    v_pk_fma_f32 v[188:189], v[200:201], v[180:181], v[188:189] op_sel_hi:[1,0,1]
    v_pk_fma_f32 v[184:185], v[202:203], v[182:183], v[184:185] op_sel_hi:[1,0,1]
    v_pk_fma_f32 v[186:187], v[204:205], v[182:183], v[186:187] op_sel_hi:[1,0,1]
    v_pk_fma_f32 v[188:189], v[206:207], v[182:183], v[188:189] op_sel_hi:[1,0,1]
    v_permlane32_swap_b32 v184, v185
    v_permlane32_swap_b32 v186, v187
    v_permlane32_swap_b32 v188, v189
    v_add_f32 v184, v184, v185
    v_add_f32 v186, v186, v187
    v_add_f32 v188, v188, v189
    v_mul_f32 v184, v210, v184
    v_mul_f32 v186, v210, v186
    v_mul_f32 v188, v210, v188
    v_mov_b32 v185, v184
    v_mov_b32 v187, v186
    v_mov_b32 v189, v188
    v_permlane32_swap_b32 v184, v185
    v_permlane32_swap_b32 v186, v187
    v_permlane32_swap_b32 v188, v189
    v_cvt_pk_bf16_f32 v212, v184, v185
    v_cvt_pk_bf16_f32 v213, v186, v187
    v_cvt_pk_bf16_f32 v214, v188, v189
    v_mov_b32 v215, s59
    s_mov_b32 exec_lo, 0
    s_mov_b32 exec_hi, 1
    v_mov_b32 v212, v208
    v_mov_b32 v213, v209
    s_mov_b32 exec_lo, -1
    s_cmp_eq_u32 s40, 0
    s_cbranch_scc1 L_s2_185
    buffer_store_dwordx4 v[212:215], v218, s[44:47], s58 offen
    s_branch L_s2e_186
L_s2_185:
    s_nop 7
    buffer_store_dwordx4 v[212:215], v218, s[44:47], s58 offen sc1
L_s2e_186:
    s_mov_b64 exec, -1
L_am_182:
    s_cmp_lg_u32 s3, 2
    s_cbranch_scc1 L_am_187
    v_lshrrev_b32 v216, 5, v1
    v_mul_u32_u24 v216, 768, v216
    v_and_b32 v217, 31, v1
    v_mul_u32_u24 v217, 24, v217
    v_add_u32 v216, v216, v217
    v_mov_b32 v217, 146240
    v_lshlrev_b32 v218, 4, v1
    s_lshl_b32 s58, s5, 5
    s_add_u32 s58, s58, s6
    s_lshl_b32 s58, s58, 10
    s_add_u32 s58, s58, 4210688
    s_and_b32 s59, s4, 0xbfffbfff
L_lw_188:
    ds_read_b32 v13, v14 offset:40
    s_waitcnt lgkmcnt(0)
    v_readfirstlane_b32 s7, v13
    s_nop 0
    s_cmp_ge_u32 s7, 4
    s_cbranch_scc1 L_lwd_189
    s_sub_u32 s52, s52, 1
    s_cbranch_scc1 L_timeout
    s_sleep 1
    s_branch L_lw_188
L_lwd_189:
    ds_read_b32 v12, v14 offset:0
    ds_read_b128 v[176:179], v217
    ds_read_b128 v[180:183], v217 offset:16
    ds_read_b64 v[184:185], v216 offset:12288
    ds_read_b64 v[186:187], v216 offset:12296
    ds_read_b64 v[188:189], v216 offset:12304
    ds_read_b64 v[190:191], v216 offset:13824
    ds_read_b64 v[192:193], v216 offset:13832
    ds_read_b64 v[194:195], v216 offset:13840
    ds_read_b64 v[196:197], v216 offset:15360
    ds_read_b64 v[198:199], v216 offset:15368
    ds_read_b64 v[200:201], v216 offset:15376
    ds_read_b64 v[202:203], v216 offset:16896
    ds_read_b64 v[204:205], v216 offset:16904
    ds_read_b64 v[206:207], v216 offset:16912
    s_waitcnt lgkmcnt(14)
    v_readfirstlane_b32 s40, v12
    s_waitcnt lgkmcnt(12)
    v_max3_f32 v208, v176, v178, v180
    v_max_f32 v208, v208, v182
    v_sub_f32 v176, v176, v208
    v_sub_f32 v178, v178, v208
    v_sub_f32 v180, v180, v208
    v_sub_f32 v182, v182, v208
    v_exp_f32 v176, v176
    v_exp_f32 v178, v178
    v_exp_f32 v180, v180
    v_exp_f32 v182, v182
    v_mul_f32 v209, v176, v177
    v_fmac_f32 v209, v178, v179
    v_fmac_f32 v209, v180, v181
    v_fmac_f32 v209, v182, v183
    v_rcp_f32 v210, v209
    s_waitcnt lgkmcnt(0)
    v_pk_mul_f32 v[184:185], v[184:185], v[176:177] op_sel_hi:[1,0]
    v_pk_mul_f32 v[186:187], v[186:187], v[176:177] op_sel_hi:[1,0]
    v_pk_mul_f32 v[188:189], v[188:189], v[176:177] op_sel_hi:[1,0]
    v_pk_fma_f32 v[184:185], v[190:191], v[178:179], v[184:185] op_sel_hi:[1,0,1]
    v_pk_fma_f32 v[186:187], v[192:193], v[178:179], v[186:187] op_sel_hi:[1,0,1]
    v_pk_fma_f32 v[188:189], v[194:195], v[178:179], v[188:189] op_sel_hi:[1,0,1]
    v_pk_fma_f32 v[184:185], v[196:197], v[180:181], v[184:185] op_sel_hi:[1,0,1]
    v_pk_fma_f32 v[186:187], v[198:199], v[180:181], v[186:187] op_sel_hi:[1,0,1]
    v_pk_fma_f32 v[188:189], v[200:201], v[180:181], v[188:189] op_sel_hi:[1,0,1]
    v_pk_fma_f32 v[184:185], v[202:203], v[182:183], v[184:185] op_sel_hi:[1,0,1]
    v_pk_fma_f32 v[186:187], v[204:205], v[182:183], v[186:187] op_sel_hi:[1,0,1]
    v_pk_fma_f32 v[188:189], v[206:207], v[182:183], v[188:189] op_sel_hi:[1,0,1]
    v_permlane32_swap_b32 v184, v185
    v_permlane32_swap_b32 v186, v187
    v_permlane32_swap_b32 v188, v189
    v_add_f32 v184, v184, v185
    v_add_f32 v186, v186, v187
    v_add_f32 v188, v188, v189
    v_mul_f32 v184, v210, v184
    v_mul_f32 v186, v210, v186
    v_mul_f32 v188, v210, v188
    v_mov_b32 v185, v184
    v_mov_b32 v187, v186
    v_mov_b32 v189, v188
    v_permlane32_swap_b32 v184, v185
    v_permlane32_swap_b32 v186, v187
    v_permlane32_swap_b32 v188, v189
    v_cvt_pk_bf16_f32 v212, v184, v185
    v_cvt_pk_bf16_f32 v213, v186, v187
    v_cvt_pk_bf16_f32 v214, v188, v189
    v_mov_b32 v215, s59
    s_mov_b32 exec_lo, 0
    s_mov_b32 exec_hi, 1
    v_mov_b32 v212, v208
    v_mov_b32 v213, v209
    s_mov_b32 exec_lo, -1
    s_cmp_eq_u32 s40, 0
    s_cbranch_scc1 L_s2_190
    buffer_store_dwordx4 v[212:215], v218, s[44:47], s58 offen
    s_branch L_s2e_191
L_s2_190:
    s_nop 7
    buffer_store_dwordx4 v[212:215], v218, s[44:47], s58 offen sc1
L_s2e_191:
    s_mov_b64 exec, -1
L_am_187:
L_lw_192:
    ds_read_b32 v13, v14 offset:44
    s_waitcnt lgkmcnt(0)
    v_readfirstlane_b32 s7, v13
    s_nop 0
    s_cmp_ge_u32 s7, 5
    s_cbranch_scc1 L_lwd_193
    s_sub_u32 s52, s52, 1
    s_cbranch_scc1 L_timeout
    s_sleep 1
    s_branch L_lw_192
L_lwd_193:
    buffer_load_dwordx4 v250, s[8:11], s57 offen nt lds
    s_add_u32 m0, m0, 1024
    s_add_u32 s57, s57, 98304
    buffer_load_dwordx4 v250, s[8:11], s57 offen nt lds
    s_add_u32 m0, m0, 1024
    s_add_u32 s57, s57, 98304
    buffer_load_dwordx4 v250, s[8:11], s57 offen nt lds
    s_add_u32 m0, m0, 1024
    s_add_u32 s57, s57, 98304
    buffer_load_dwordx4 v250, s[8:11], s57 offen nt lds
    s_waitcnt vmcnt(0)
    s_mov_b64 exec, 1
    v_mov_b32 v13, 1
    ds_add_u32 v14, v13 offset:12
    s_mov_b64 exec, -1
L_lw_194:
    ds_read_b32 v13, v14 offset:12
    s_waitcnt lgkmcnt(0)
    v_readfirstlane_b32 s7, v13
    s_nop 0
    s_cmp_ge_u32 s7, 4
    s_cbranch_scc1 L_lwd_195
    s_sub_u32 s52, s52, 1
    s_cbranch_scc1 L_timeout
    s_branch L_lw_194
L_lwd_195:
    ds_read_b64_tr_b16 v[80:81], v251 offset:0
    ds_read_b64_tr_b16 v[104:105], v251 offset:20480
    ds_read_b64_tr_b16 v[82:83], v251 offset:512
    ds_read_b64_tr_b16 v[106:107], v251 offset:20992
    ds_read_b64_tr_b16 v[84:85], v251 offset:1024
    ds_read_b64_tr_b16 v[108:109], v251 offset:21504
    ds_read_b64_tr_b16 v[86:87], v251 offset:1536
    ds_read_b64_tr_b16 v[110:111], v251 offset:22016
    ds_read_b64_tr_b16 v[88:89], v251 offset:8192
    ds_read_b64_tr_b16 v[112:113], v251 offset:28672
    ds_read_b64_tr_b16 v[90:91], v251 offset:8704
    ds_read_b64_tr_b16 v[114:115], v251 offset:29184
    ds_read_b64_tr_b16 v[92:93], v251 offset:9216
    ds_read_b64_tr_b16 v[116:117], v251 offset:29696
    ds_read_b64_tr_b16 v[94:95], v251 offset:9728
    ds_read_b64_tr_b16 v[118:119], v251 offset:30208
    ds_read_b64_tr_b16 v[96:97], v251 offset:16384
    ds_read_b64_tr_b16 v[120:121], v251 offset:36864
    ds_read_b64_tr_b16 v[98:99], v251 offset:16896
    ds_read_b64_tr_b16 v[122:123], v251 offset:37376
    ds_read_b64_tr_b16 v[100:101], v251 offset:17408
    ds_read_b64_tr_b16 v[124:125], v251 offset:37888
    ds_read_b64_tr_b16 v[102:103], v251 offset:17920
    ds_read_b64_tr_b16 v[126:127], v251 offset:38400
    s_waitcnt lgkmcnt(0)
L_G:
    s_mul_i32 s56, s74, 10
    s_cmp_ge_u32 s56, 40
    s_cselect_b32 s58, 40, 0
    s_cselect_b32 s59, 1, 0
    s_sub_u32 s58, s56, s58
    s_xor_b32 s59, s59, s41
    s_lshl_b32 s59, s59, 13
    s_and_b32 s7, s58, 1
    s_lshl_b32 s7, s7, 12
    s_add_u32 s59, s59, s7
    s_lshr_b32 s58, s58, 1
    s_lshl_b32 s58, s58, 14
    s_add_u32 s56, s58, s59
    s_add_u32 s56, s56, 2097152
    s_lshl_b32 s68, s3, 10
    s_add_u32 s68, s68, s27
    s_add_u32 s69, s68, 4096
    s_add_u32 s70, s68, 16384
    s_cmp_lt_u32 s3, 2
    s_cselect_b32 s70, s70, s69
L_lw_196:
    ds_read_b32 v13, v14 offset:44
    s_waitcnt lgkmcnt(0)
    v_readfirstlane_b32 s7, v13
    s_nop 0
    s_cmp_ge_u32 s7, 4
    s_cbranch_scc1 L_lwd_197
    s_sub_u32 s52, s52, 1
    s_cbranch_scc1 L_timeout
    s_sleep 4
    s_branch L_lw_196
L_lwd_197:
L_gp_198:
    buffer_load_dwordx4 v[176:179], v4, s[44:47], s56 offen offset:0 sc1
    s_waitcnt vmcnt(0)
    v_perm_b32 v244, v177, v176, s62
    v_perm_b32 v245, v179, v178, s63
    v_bitop3_b32 v12, v244, v245, v234 bitop3:0x56
    v_cmp_ne_u32 vcc, 0, v12
    s_cbranch_vccz L_gpd_199
    s_mov_b64 exec, vcc
    s_sub_u32 s52, s52, 1
    s_cbranch_scc1 L_timeout
    s_sleep 2
    s_branch L_gp_198
L_gpd_199:
    s_mov_b64 exec, -1
    v_and_b32 v176, s61, v176
    v_and_b32 v177, s61, v177
    v_and_b32 v178, s61, v178
    v_and_b32 v179, s61, v179
L_gf_200:
    buffer_load_dwordx3 v[176:178], v249, s[44:47], s68 offen offset:0 sc1
    buffer_load_dwordx3 v[180:182], v249, s[44:47], s69 offen offset:0 sc1
    buffer_load_dwordx3 v[184:186], v249, s[44:47], s70 offen offset:0 sc1
    s_waitcnt vmcnt(1)
    v_min_u32 v12, v178, v182
    v_max_u32 v13, v178, v182
    s_waitcnt vmcnt(0)
    v_min_u32 v12, v12, v186
    v_max_u32 v13, v13, v186
    v_cmp_ne_u32 s[58:59], s4, v12
    v_cmp_ne_u32 vcc, s4, v13
    s_nop 0
    s_or_b64 s[58:59], s[58:59], vcc
    s_cbranch_scc0 L_gfd_201
    s_sub_u32 s52, s52, 1
    s_cbranch_scc1 L_timeout
    s_branch L_gf_200
L_gfd_201:
    v_lshlrev_b32 v228, 16, v176
    v_and_b32 v229, s53, v176
    v_lshlrev_b32 v230, 16, v177
    v_and_b32 v231, s53, v177
    v_pk_mul_f32 v[228:229], v[228:229], v[152:153]
    v_pk_mul_f32 v[230:231], v[230:231], v[154:155]
    v_cvt_pk_bf16_f32 v232, v228, v229
    v_cvt_pk_bf16_f32 v233, v230, v231
    v_dot2_f32_bf16 v216, v176, s26, 0
    v_dot2_f32_bf16 v218, v176, v176, 0
    v_mov_b32_dpp v46, v232 quad_perm:[0,1,2,3] row_mask:0xf bank_mask:0x1
    v_mov_b32_dpp v47, v233 quad_perm:[0,1,2,3] row_mask:0xf bank_mask:0x1
    v_mov_b32_dpp v48, v232 row_shl:4 row_mask:0xf bank_mask:0x1
    v_mov_b32_dpp v49, v233 row_shl:4 row_mask:0xf bank_mask:0x1
    v_mov_b32_dpp v50, v232 row_shl:8 row_mask:0xf bank_mask:0x1
    v_mov_b32_dpp v51, v233 row_shl:8 row_mask:0xf bank_mask:0x1
    v_mov_b32_dpp v52, v232 row_shl:12 row_mask:0xf bank_mask:0x1
    v_mov_b32_dpp v53, v233 row_shl:12 row_mask:0xf bank_mask:0x1
    v_dot2_f32_bf16 v217, v177, s26, 0
    v_dot2_f32_bf16 v219, v177, v177, 0
    v_mfma_f32_16x16x32_bf16 v[16:19], v[80:83], v[46:49], 0
    v_lshlrev_b32 v228, 16, v180
    v_and_b32 v229, s53, v180
    v_lshlrev_b32 v230, 16, v181
    v_and_b32 v231, s53, v181
    v_pk_mul_f32 v[228:229], v[228:229], v[156:157]
    v_mfma_f32_16x16x32_bf16 v[20:23], v[104:107], v[46:49], 0
    v_pk_mul_f32 v[230:231], v[230:231], v[158:159]
    v_cvt_pk_bf16_f32 v232, v228, v229
    v_cvt_pk_bf16_f32 v233, v230, v231
    v_dot2_f32_bf16 v216, v180, s26, v216
    v_dot2_f32_bf16 v218, v180, v180, v218
    v_mfma_f32_16x16x32_bf16 v[16:19], v[84:87], v[50:53], v[16:19]
    v_mov_b32_dpp v54, v232 quad_perm:[0,1,2,3] row_mask:0xf bank_mask:0x1
    v_mov_b32_dpp v55, v233 quad_perm:[0,1,2,3] row_mask:0xf bank_mask:0x1
    v_mov_b32_dpp v56, v232 row_shl:4 row_mask:0xf bank_mask:0x1
    v_mov_b32_dpp v57, v233 row_shl:4 row_mask:0xf bank_mask:0x1
    v_mov_b32_dpp v58, v232 row_shl:8 row_mask:0xf bank_mask:0x1
    v_mfma_f32_16x16x32_bf16 v[20:23], v[108:111], v[50:53], v[20:23]
    v_mov_b32_dpp v59, v233 row_shl:8 row_mask:0xf bank_mask:0x1
    v_mov_b32_dpp v60, v232 row_shl:12 row_mask:0xf bank_mask:0x1
    v_mov_b32_dpp v61, v233 row_shl:12 row_mask:0xf bank_mask:0x1
    v_dot2_f32_bf16 v217, v181, s26, v217
    v_dot2_f32_bf16 v219, v181, v181, v219
    s_cmp_ge_u32 s3, 2
    s_cbranch_scc1 L_g1
    v_mfma_f32_16x16x32_bf16 v[16:19], v[88:91], v[54:57], v[16:19]
    v_lshlrev_b32 v228, 16, v184
    v_and_b32 v229, s53, v184
    v_lshlrev_b32 v230, 16, v185
    v_and_b32 v231, s53, v185
    v_pk_mul_f32 v[228:229], v[228:229], v[160:161]
    v_mfma_f32_16x16x32_bf16 v[20:23], v[112:115], v[54:57], v[20:23]
    v_pk_mul_f32 v[230:231], v[230:231], v[162:163]
    v_cvt_pk_bf16_f32 v232, v228, v229
    v_cvt_pk_bf16_f32 v233, v230, v231
    v_dot2_f32_bf16 v216, v184, s26, v216
    v_dot2_f32_bf16 v218, v184, v184, v218
    v_mfma_f32_16x16x32_bf16 v[16:19], v[92:95], v[58:61], v[16:19]
    v_mov_b32_dpp v62, v232 quad_perm:[0,1,2,3] row_mask:0xf bank_mask:0x1
    v_mov_b32_dpp v63, v233 quad_perm:[0,1,2,3] row_mask:0xf bank_mask:0x1
    v_mov_b32_dpp v64, v232 row_shl:4 row_mask:0xf bank_mask:0x1
    v_mov_b32_dpp v65, v233 row_shl:4 row_mask:0xf bank_mask:0x1
    v_mov_b32_dpp v66, v232 row_shl:8 row_mask:0xf bank_mask:0x1
    v_mfma_f32_16x16x32_bf16 v[20:23], v[116:119], v[58:61], v[20:23]
    v_mov_b32_dpp v67, v233 row_shl:8 row_mask:0xf bank_mask:0x1
    v_mov_b32_dpp v68, v232 row_shl:12 row_mask:0xf bank_mask:0x1
    v_mov_b32_dpp v69, v233 row_shl:12 row_mask:0xf bank_mask:0x1
    v_dot2_f32_bf16 v217, v185, s26, v217
    v_dot2_f32_bf16 v219, v185, v185, v219
    v_mfma_f32_16x16x32_bf16 v[16:19], v[96:99], v[62:65], v[16:19]
    v_mfma_f32_16x16x32_bf16 v[20:23], v[120:123], v[62:65], v[20:23]
    v_mfma_f32_16x16x32_bf16 v[16:19], v[100:103], v[66:69], v[16:19]
    v_mfma_f32_16x16x32_bf16 v[20:23], v[124:127], v[66:69], v[20:23]
    s_branch L_g2
L_g1:
    v_mfma_f32_16x16x32_bf16 v[16:19], v[88:91], v[54:57], v[16:19]
    v_mfma_f32_16x16x32_bf16 v[20:23], v[112:115], v[54:57], v[20:23]
    v_mfma_f32_16x16x32_bf16 v[16:19], v[92:95], v[58:61], v[16:19]
    v_mfma_f32_16x16x32_bf16 v[20:23], v[116:119], v[58:61], v[20:23]
L_g2:
    v_add_f32 v216, v216, v217
    v_add_f32 v218, v218, v219
    s_nop 0
    v_add_f32_dpp v216, v216, v216 row_ror:4 row_mask:0xf bank_mask:0xf
    v_add_f32_dpp v218, v218, v218 row_ror:4 row_mask:0xf bank_mask:0xf
    s_nop 0
    v_add_f32_dpp v216, v216, v216 row_ror:8 row_mask:0xf bank_mask:0xf
    v_add_f32_dpp v218, v218, v218 row_ror:8 row_mask:0xf bank_mask:0xf
    s_nop 1
    v_permlane16_swap_b32 v216, v218
    v_add_f32 v216, v216, v218
    v_mov_b32 v218, v216
    s_nop 1
    v_permlane32_swap_b32 v216, v218
    v_add_f32 v216, v216, v218
    s_mov_b32 exec_lo, 0xf000f
    s_mov_b32 exec_hi, 0x0
    ds_write_b32 v5, v216
    s_mov_b64 exec, -1
    s_nop 1
    ds_write_b128 v252, v[16:19]
    ds_write_b128 v252, v[20:23] offset:4096
    s_waitcnt lgkmcnt(0)
    s_barrier
    s_cmp_lg_u32 s3, 0
    s_cbranch_scc1 L_gend
    ds_read_b64 v[72:73], v6 offset:0
    ds_read_b64 v[74:75], v6 offset:32
    ds_read_b64 v[76:77], v6 offset:64
    ds_read_b64 v[78:79], v6 offset:96
    ds_read_b128 v[24:27], v248 offset:1024
    ds_read_b128 v[28:31], v248 offset:2048
    ds_read_b128 v[32:35], v248 offset:3072
    ds_read_b128 v[36:39], v248 offset:5120
    ds_read_b128 v[40:43], v248 offset:6144
    ds_read_b128 v[44:47], v248 offset:7168
    s_waitcnt lgkmcnt(6)
    v_pk_add_f32 v[72:73], v[72:73], v[74:75]
    v_pk_add_f32 v[76:77], v[76:77], v[78:79]
    v_add_f32 v216, v72, v76
    v_add_f32 v218, v73, v77
    v_mul_f32 v220, 0xbacccccd, v216
    v_mul_f32 v218, 0x3acccccd, v218
    v_fma_f32 v218, -v220, v220, v218
    v_max_f32 v218, 0, v218
    v_add_f32 v218, 0x3727c5ac, v218
    v_rsq_f32 v222, v218
    s_waitcnt lgkmcnt(3)
    v_pk_add_f32 v[16:17], v[16:17], v[24:25]
    v_pk_add_f32 v[28:29], v[28:29], v[32:33]
    v_pk_add_f32 v[18:19], v[18:19], v[26:27]
    v_pk_add_f32 v[30:31], v[30:31], v[34:35]
    v_pk_add_f32 v[16:17], v[16:17], v[28:29]
    v_pk_add_f32 v[18:19], v[18:19], v[30:31]
    s_waitcnt lgkmcnt(0)
    v_pk_add_f32 v[20:21], v[20:21], v[36:37]
    v_pk_add_f32 v[40:41], v[40:41], v[44:45]
    v_pk_add_f32 v[22:23], v[22:23], v[38:39]
    v_pk_add_f32 v[42:43], v[42:43], v[46:47]
    v_pk_add_f32 v[20:21], v[20:21], v[40:41]
    v_pk_add_f32 v[22:23], v[22:23], v[42:43]
    v_fmac_f32_dpp v16, v16, v220 row_shl:4 row_mask:0xf bank_mask:0x1
    v_fmac_f32_dpp v17, v17, v220 row_shl:4 row_mask:0xf bank_mask:0x1
    v_fmac_f32_dpp v18, v18, v220 row_shl:4 row_mask:0xf bank_mask:0x1
    v_fmac_f32_dpp v19, v19, v220 row_shl:4 row_mask:0xf bank_mask:0x1
    v_fmac_f32_dpp v20, v20, v220 row_shl:4 row_mask:0xf bank_mask:0x1
    v_fmac_f32_dpp v21, v21, v220 row_shl:4 row_mask:0xf bank_mask:0x1
    v_fmac_f32_dpp v22, v22, v220 row_shl:4 row_mask:0xf bank_mask:0x1
    v_fmac_f32_dpp v23, v23, v220 row_shl:4 row_mask:0xf bank_mask:0x1
    v_mov_b32_dpp v24, v16 row_shl:8 row_mask:0xf bank_mask:0x1
    v_mov_b32_dpp v25, v17 row_shl:8 row_mask:0xf bank_mask:0x1
    v_mov_b32_dpp v26, v18 row_shl:8 row_mask:0xf bank_mask:0x1
    v_mov_b32_dpp v27, v19 row_shl:8 row_mask:0xf bank_mask:0x1
    v_mov_b32_dpp v28, v20 row_shl:8 row_mask:0xf bank_mask:0x1
    v_mov_b32_dpp v29, v21 row_shl:8 row_mask:0xf bank_mask:0x1
    v_mov_b32_dpp v30, v22 row_shl:8 row_mask:0xf bank_mask:0x1
    v_mov_b32_dpp v31, v23 row_shl:8 row_mask:0xf bank_mask:0x1
    v_pk_fma_f32 v[16:17], v[16:17], v[222:223], v[24:25] op_sel_hi:[1,0,1]
    v_pk_fma_f32 v[18:19], v[18:19], v[222:223], v[26:27] op_sel_hi:[1,0,1]
    v_pk_fma_f32 v[20:21], v[20:21], v[222:223], v[28:29] op_sel_hi:[1,0,1]
    v_pk_fma_f32 v[22:23], v[22:23], v[222:223], v[30:31] op_sel_hi:[1,0,1]
    v_mul_f32 v32, v16, v16
    v_mul_f32 v33, v17, v17
    v_mul_f32 v34, v18, v18
    v_mul_f32 v35, v19, v19
    v_fma_f32 v32, v32, s51, v253
    v_fma_f32 v33, v33, s51, v253
    v_fma_f32 v34, v34, s51, v253
    v_fma_f32 v35, v35, s51, v253
    v_mul_f32 v32, v32, v16
    v_mul_f32 v33, v33, v17
    v_mul_f32 v34, v34, v18
    v_mul_f32 v35, v35, v19
    v_exp_f32 v32, v32
    v_exp_f32 v33, v33
    v_exp_f32 v34, v34
    v_exp_f32 v35, v35
    v_pk_mul_f32 v[16:17], v[16:17], v[20:21]
    v_pk_mul_f32 v[18:19], v[18:19], v[22:23]
    v_add_f32 v32, 1.0, v32
    v_add_f32 v33, 1.0, v33
    v_add_f32 v34, 1.0, v34
    v_add_f32 v35, 1.0, v35
    v_rcp_f32 v32, v32
    v_rcp_f32 v33, v33
    v_rcp_f32 v34, v34
    v_rcp_f32 v35, v35
    v_pk_mul_f32 v[16:17], v[16:17], v[32:33]
    v_pk_mul_f32 v[18:19], v[18:19], v[34:35]
    v_cvt_pk_bf16_f32 v28, v16, v17
    v_cvt_pk_bf16_f32 v29, v18, v19
    s_nop 0
    v_mov_b32_dpp v28, v28 row_shr:4 row_mask:0xf bank_mask:0x2
    v_mov_b32_dpp v29, v29 row_shr:4 row_mask:0xf bank_mask:0x2
    s_nop 0
    v_mov_b32_dpp v28, v28 row_shr:8 row_mask:0xf bank_mask:0x4
    v_mov_b32_dpp v29, v29 row_shr:8 row_mask:0xf bank_mask:0x4
    s_nop 0
    v_mov_b32_dpp v28, v28 row_shr:12 row_mask:0xf bank_mask:0x8
    v_mov_b32_dpp v29, v29 row_shr:12 row_mask:0xf bank_mask:0x8
    v_mov_b32 v30, s4
    buffer_store_dwordx4 v[28:31], v11, s[44:47], s48 offen sc1
L_gend:
    s_mov_b64 exec, -1
    s_add_u32 s3, s3, 4
    s_endpgm
.section .rodata,"a"
.p2align 6
.amdhsa_kernel adaLN_cond__gqa_block_cached__geglu_ffn__decode_kernel
  .amdhsa_next_free_vgpr 256
  .amdhsa_next_free_sgpr 102
  .amdhsa_accum_offset 256
  .amdhsa_group_segment_fixed_size 0
  .amdhsa_kernarg_size 112
  .amdhsa_user_sgpr_count 2
  .amdhsa_user_sgpr_kernarg_segment_ptr 1
  .amdhsa_system_sgpr_workgroup_id_x 1
  .amdhsa_float_denorm_mode_32 3
.end_amdhsa_kernel
```
